```python
import torch

def _softmax(x, axis=-1):
    return torch.softmax(x, dim=axis)
def _gelu(x):
    return torch.nn.functional.gelu(x, approximate="tanh")
def _silu(x):
    return torch.nn.functional.silu(x)
def _sigmoid(x):
    return torch.sigmoid(x)
def _layernorm(x, axis=-1, eps=1e-5):
    m = x.mean(dim=axis, keepdim=True)
    v = x.var(dim=axis, keepdim=True, unbiased=False)
    return (x - m) / torch.sqrt(v + eps)
def _scatter_add(tgt, idx, src, axis=0):
    return tgt.clone().index_add_(axis, idx, src)
def _segment_sum(src, seg, n):
    out = torch.zeros((n,) + src.shape[1:], dtype=src.dtype)
    return out.index_add_(0, seg, src)
def _pad(x, pw):
    flat = tuple(v for pair in reversed(pw) for v in pair)
    return torch.nn.functional.pad(x, flat)

kernel_name = 'recurrent_scan__spectral_fnet__glu_gated_reglu__prompt'

def setup_inputs():

    _w = (lambda a: (lambda t: t.to(torch.bfloat16) if t.is_floating_point() else t)(torch.as_tensor(a)))
    def _A_setup():
        B, S, D = 1, 2048, 512
        ns = torch.arange(S)[:, None] * torch.arange(S)[None, :]
        nd = torch.arange(D)[:, None] * torch.arange(D)[None, :]
        Ws_re = torch.cos(-2.0 * torch.pi * ns / S).to(float)
        Ws_im = torch.sin(-2.0 * torch.pi * ns / S).to(float)
        Wd_re = torch.cos(-2.0 * torch.pi * nd / D).to(float)
        Wd_im = torch.sin(-2.0 * torch.pi * nd / D).to(float)
        return {
            "x": _w((lambda *s: torch.randn(*s, dtype=torch.bfloat16) * 0.05)(B, S, D)),
            "dft_seq_re": _w(Ws_re),
            "dft_seq_im": _w(Ws_im),
            "dft_hid_re": _w(Wd_re),
            "dft_hid_im": _w(Wd_im),
        }
    _A_in = _A_setup()

    def _B_setup():
        B, S, D, F = 1, 2048, 512, 1792
        return {
            "x": _w((lambda *s: torch.randn(*s, dtype=torch.bfloat16) * 0.05)(B, S, D)),
            "W_gate": _w((lambda *s: torch.randn(*s, dtype=torch.bfloat16) * 0.05)(D, F) * (2.0 / D) ** 0.5),
            "W_up": _w((lambda *s: torch.randn(*s, dtype=torch.bfloat16) * 0.05)(D, F) * (2.0 / D) ** 0.5),
            "W_down": _w((lambda *s: torch.randn(*s, dtype=torch.bfloat16) * 0.05)(F, D) * (1.0 / F) ** 0.5),
        }
    _B_in = _B_setup()

    return {
        "A_x": _A_in["x"],
        "A_dft_seq_re": _A_in["dft_seq_re"],
        "A_dft_seq_im": _A_in["dft_seq_im"],
        "A_dft_hid_re": _A_in["dft_hid_re"],
        "A_dft_hid_im": _A_in["dft_hid_im"],
        "B_x": _B_in["x"],
        "B_W_gate": _B_in["W_gate"],
        "B_W_up": _B_in["W_up"],
        "B_W_down": _B_in["W_down"],
    }

def reference(A_x, A_dft_seq_re, A_dft_seq_im, A_dft_hid_re, A_dft_hid_im, B_x, B_W_gate, B_W_up, B_W_down):
    def _A_ref(x, dft_seq_re, dft_seq_im, dft_hid_re, dft_hid_im):
        a = torch.einsum("bsd,ed->bse", x, dft_hid_re)
        b = torch.einsum("bsd,ed->bse", x, dft_hid_im)
        y = torch.einsum("ts,bse->bte", dft_seq_re, a) - torch.einsum("ts,bse->bte", dft_seq_im, b)
        return y

    def _B_ref(x, W_gate, W_up, W_down):
        gate = torch.einsum("bsd,df->bsf", x, W_gate)
        up = torch.einsum("bsd,df->bsf", x, W_up)
        gate = gate * (lambda x, dt: x.to(dt))(gate > 0, gate.dtype)
        h = gate * up
        return torch.einsum("bsf,fd->bsd", h, W_down)

    x = A_x
    xn = _layernorm(x, axis=-1)
    s = _A_ref(xn, A_dft_seq_re, A_dft_seq_im, A_dft_hid_re, A_dft_hid_im)
    g = _silu(_B_ref(xn, B_W_gate, B_W_up, B_W_down))
    return x + s * g
```

```asm
; @launch kernel=fnet_k1_kernel grid=(256,1,1) block=(512,1,1) lds=163840
; @launch kernel=fnet_k2_kernel grid=(256,1,1) block=(256,1,1) lds=99328
.amdgcn_target "amdgcn-amd-amdhsa--gfx950"
.text
.globl fnet_k1_kernel
.p2align 8
.type fnet_k1_kernel,@function
fnet_k1_kernel:
    s_cmp_ge_u32 s2, 256
    s_cbranch_scc1 K1_END
    s_load_dwordx4 s[36:39], s[0:1], 0
    s_load_dwordx4 s[40:43], s[0:1], 16
    s_load_dwordx2 s[44:45], s[0:1], 32
    s_load_dwordx4 s[48:51], s[0:1], 48
    s_load_dwordx2 s[52:53], s[0:1], 64
    s_load_dwordx2 s[54:55], s[0:1], 88
    s_and_b32 s3, s2, 7
    s_lshr_b32 s4, s2, 3
    s_and_b32 s5, s3, 1
    s_lshl_b32 s5, s5, 3
    s_and_b32 s6, s4, 7
    s_add_u32 s5, s5, s6
    s_lshr_b32 s6, s3, 1
    s_lshl_b32 s6, s6, 2
    s_lshr_b32 s7, s4, 3
    s_add_u32 s6, s6, s7
    v_and_b32 v1, 63, v0
    v_lshrrev_b32 v2, 6, v0
    s_nop 0
    v_readfirstlane_b32 s7, v2
    s_cmp_ge_u32 s6, 14
    s_cselect_b32 s56, 1, 0
    v_lshrrev_b32 v3, 3, v1
    v_and_b32 v4, 7, v1
    s_cmp_eq_u32 s56, 1
    s_cbranch_scc1 K1_ROWS_DFT
    s_lshr_b32 s8, s7, 1
    s_lshl_b32 s9, s5, 2
    s_add_u32 s8, s8, s9
    s_and_b32 s9, s7, 1
    s_lshl_b32 s9, s9, 4
    s_lshr_b32 s10, s8, 1
    s_lshl_b32 s10, s10, 5
    s_add_u32 s9, s9, s10
    v_add_u32 v5, s9, v3
    v_add_u32 v6, 8, v5
    s_and_b32 s8, s8, 1
    s_cmp_eq_u32 s8, 0
    s_cbranch_scc1 K1_ROWS_A
    v_sub_u32 v5, 0x800, v5
    v_cmp_eq_u32 vcc, 0x800, v5
    v_mov_b32 v7, 0x400
    s_nop 0
    v_cndmask_b32 v5, v5, v7, vcc
    v_sub_u32 v6, 0x800, v6
    v_cmp_eq_u32 vcc, 0x800, v6
    v_mov_b32 v7, 0x400
    s_nop 0
    v_cndmask_b32 v6, v6, v7, vcc
K1_ROWS_A:
    s_lshl_b32 s9, s7, 4
    v_add_u32 v7, s9, v3
    v_add_u32 v8, 8, v7
    s_branch K1_ROWS_DONE
K1_ROWS_DFT:
    s_lshl_b32 s9, s5, 6
    s_lshl_b32 s10, s7, 3
    s_add_u32 s9, s9, s10
    v_add_u32 v5, s9, v3
    v_mov_b32 v6, v5
    v_sub_u32 v6, 0x800, v6
    v_cmp_eq_u32 vcc, 0x800, v6
    v_mov_b32 v7, 0x400
    s_nop 0
    v_cndmask_b32 v6, v6, v7, vcc
    v_add_u32 v7, s10, v3
    v_add_u32 v8, 64, v7
K1_ROWS_DONE:
    v_lshlrev_b32 v9, 4, v4
    v_lshl_add_u32 v5, v5, 10, v9
    v_lshl_add_u32 v6, v6, 10, v9
    v_and_b32 v10, 15, v7
    v_xor_b32 v10, v10, v4
    v_lshlrev_b32 v10, 4, v10
    v_lshl_add_u32 v7, v7, 9, v10
    v_and_b32 v10, 15, v8
    v_xor_b32 v10, v10, v4
    v_lshlrev_b32 v10, 4, v10
    v_lshl_add_u32 v8, v8, 9, v10
    s_waitcnt lgkmcnt(0)
    s_mov_b32 s8, s36
    s_and_b32 s9, s37, 0xffff
    s_mov_b32 s10, 0x200000
    s_mov_b32 s11, 0x20000
    s_mov_b32 s32, s54
    s_and_b32 s33, s55, 0xffff
    s_mov_b32 s34, 0xdc0400
    s_mov_b32 s35, 0x20000
    buffer_load_dwordx4 v[64:67], v5, s[8:11], 0 offen offset:0
    buffer_load_dwordx4 v[68:71], v5, s[8:11], 0 offen offset:128
    buffer_load_dwordx4 v[72:75], v5, s[8:11], 0 offen offset:256
    buffer_load_dwordx4 v[76:79], v5, s[8:11], 0 offen offset:384
    buffer_load_dwordx4 v[80:83], v5, s[8:11], 0 offen offset:512
    buffer_load_dwordx4 v[84:87], v5, s[8:11], 0 offen offset:640
    buffer_load_dwordx4 v[88:91], v5, s[8:11], 0 offen offset:768
    buffer_load_dwordx4 v[92:95], v5, s[8:11], 0 offen offset:896
    buffer_load_dwordx4 v[96:99], v6, s[8:11], 0 offen offset:0
    buffer_load_dwordx4 v[100:103], v6, s[8:11], 0 offen offset:128
    buffer_load_dwordx4 v[104:107], v6, s[8:11], 0 offen offset:256
    buffer_load_dwordx4 v[108:111], v6, s[8:11], 0 offen offset:384
    buffer_load_dwordx4 v[112:115], v6, s[8:11], 0 offen offset:512
    buffer_load_dwordx4 v[116:119], v6, s[8:11], 0 offen offset:640
    buffer_load_dwordx4 v[120:123], v6, s[8:11], 0 offen offset:768
    buffer_load_dwordx4 v[124:127], v6, s[8:11], 0 offen offset:896
    s_cmp_eq_u32 s56, 1
    s_cselect_b32 s48, s42, s48
    s_cselect_b32 s49, s43, s49
    s_cselect_b32 s50, s44, s50
    s_cselect_b32 s51, s45, s51
    s_mov_b32 s57, 3584
    s_mov_b32 s59, 0x1C0000
    s_cselect_b32 s57, 1024, s57
    s_cselect_b32 s59, 0x80000, s59
    s_mov_b32 s12, s48
    s_and_b32 s13, s49, 0xffff
    s_mov_b32 s14, 0x0
    s_mov_b32 s15, 0x20000
    s_mov_b32 s16, s50
    s_and_b32 s17, s51, 0xffff
    s_mov_b32 s18, 0x0
    s_mov_b32 s19, 0x20000
    s_mov_b32 s14, s59
    s_mov_b32 s18, s59
    s_sub_u32 s58, s6, 14
    s_cmp_eq_u32 s56, 1
    s_cselect_b32 s58, s58, s6
    s_lshl_b32 s58, s58, 8
    v_lshrrev_b32 v10, 4, v1
    s_lshl_b32 s20, s7, 3
    v_add_u32 v11, s20, v10
    v_mul_lo_u32 v11, v11, s57
    v_lshlrev_b32 v10, 2, v10
    v_and_b32 v12, 15, v1
    v_xor_b32 v10, v10, v12
    v_lshl_add_u32 v11, v10, 4, v11
    v_add_u32 v11, s58, v11
    s_lshl_b32 s60, s57, 2
    s_lshl_b32 s61, s57, 6
    s_lshl_b32 s62, s7, 11
    v_and_b32 v12, 31, v1
    v_lshrrev_b32 v13, 5, v1
    v_mov_b32 v48, 0x3f803f80
    v_mov_b32 v49, v48
    v_and_b32 v2, 1, v1
    v_cmp_eq_u32 s[20:21], 1, v2
    v_and_b32 v2, 2, v1
    v_cmp_eq_u32 s[22:23], 2, v2
    v_xor_b32 v5, 128, v7
    v_xor_b32 v6, 128, v8
    v_mov_b32 v16, 0
    v_mov_b32 v18, 0
    s_mov_b32 s67, 0x3f803f80
    v_mov_b32 v17, 0
    v_mov_b32 v19, 0
    v_mov_b32 v20, 0
    v_mov_b32 v21, 0
    v_mov_b32 v22, 0
    v_mov_b32 v23, 0
    s_waitcnt vmcnt(8)
    v_dot2_f32_bf16 v17, v64, v64, v17
    v_dot2_f32_bf16 v16, v64, s67, v16
    v_dot2_f32_bf16 v21, v65, v65, v21
    v_dot2_f32_bf16 v20, v65, s67, v20
    v_dot2_f32_bf16 v17, v66, v66, v17
    v_dot2_f32_bf16 v16, v66, s67, v16
    v_dot2_f32_bf16 v21, v67, v67, v21
    v_dot2_f32_bf16 v20, v67, s67, v20
    v_dot2_f32_bf16 v17, v68, v68, v17
    v_dot2_f32_bf16 v16, v68, s67, v16
    v_dot2_f32_bf16 v21, v69, v69, v21
    v_dot2_f32_bf16 v20, v69, s67, v20
    v_dot2_f32_bf16 v17, v70, v70, v17
    v_dot2_f32_bf16 v16, v70, s67, v16
    v_dot2_f32_bf16 v21, v71, v71, v21
    v_dot2_f32_bf16 v20, v71, s67, v20
    v_dot2_f32_bf16 v17, v72, v72, v17
    v_dot2_f32_bf16 v16, v72, s67, v16
    v_dot2_f32_bf16 v21, v73, v73, v21
    v_dot2_f32_bf16 v20, v73, s67, v20
    v_dot2_f32_bf16 v17, v74, v74, v17
    v_dot2_f32_bf16 v16, v74, s67, v16
    v_dot2_f32_bf16 v21, v75, v75, v21
    v_dot2_f32_bf16 v20, v75, s67, v20
    v_dot2_f32_bf16 v17, v76, v76, v17
    v_dot2_f32_bf16 v16, v76, s67, v16
    v_dot2_f32_bf16 v21, v77, v77, v21
    v_dot2_f32_bf16 v20, v77, s67, v20
    v_dot2_f32_bf16 v17, v78, v78, v17
    v_dot2_f32_bf16 v16, v78, s67, v16
    v_dot2_f32_bf16 v21, v79, v79, v21
    v_dot2_f32_bf16 v20, v79, s67, v20
    v_dot2_f32_bf16 v17, v80, v80, v17
    v_dot2_f32_bf16 v16, v80, s67, v16
    v_dot2_f32_bf16 v21, v81, v81, v21
    v_dot2_f32_bf16 v20, v81, s67, v20
    v_dot2_f32_bf16 v17, v82, v82, v17
    v_dot2_f32_bf16 v16, v82, s67, v16
    v_dot2_f32_bf16 v21, v83, v83, v21
    v_dot2_f32_bf16 v20, v83, s67, v20
    v_dot2_f32_bf16 v17, v84, v84, v17
    v_dot2_f32_bf16 v16, v84, s67, v16
    v_dot2_f32_bf16 v21, v85, v85, v21
    v_dot2_f32_bf16 v20, v85, s67, v20
    v_dot2_f32_bf16 v17, v86, v86, v17
    v_dot2_f32_bf16 v16, v86, s67, v16
    v_dot2_f32_bf16 v21, v87, v87, v21
    v_dot2_f32_bf16 v20, v87, s67, v20
    v_dot2_f32_bf16 v17, v88, v88, v17
    v_dot2_f32_bf16 v16, v88, s67, v16
    v_dot2_f32_bf16 v21, v89, v89, v21
    v_dot2_f32_bf16 v20, v89, s67, v20
    v_dot2_f32_bf16 v17, v90, v90, v17
    v_dot2_f32_bf16 v16, v90, s67, v16
    v_dot2_f32_bf16 v21, v91, v91, v21
    v_dot2_f32_bf16 v20, v91, s67, v20
    v_dot2_f32_bf16 v17, v92, v92, v17
    v_dot2_f32_bf16 v16, v92, s67, v16
    v_dot2_f32_bf16 v21, v93, v93, v21
    v_dot2_f32_bf16 v20, v93, s67, v20
    v_dot2_f32_bf16 v17, v94, v94, v17
    v_dot2_f32_bf16 v16, v94, s67, v16
    v_dot2_f32_bf16 v21, v95, v95, v21
    v_dot2_f32_bf16 v20, v95, s67, v20
    s_waitcnt vmcnt(0)
    s_mul_i32 s63, s61, 0
    s_add_u32 s64, s63, s60
    s_add_u32 m0, s62, 65536
    s_nop 0
    buffer_load_dwordx4 v11, s[12:15], s63 offen lds
    s_add_u32 m0, s62, 66560
    s_nop 0
    buffer_load_dwordx4 v11, s[12:15], s64 offen lds
    s_add_u32 m0, s62, 81920
    s_nop 0
    buffer_load_dwordx4 v11, s[16:19], s63 offen lds
    s_add_u32 m0, s62, 82944
    s_nop 0
    buffer_load_dwordx4 v11, s[16:19], s64 offen lds
    s_mul_i32 s63, s61, 1
    s_add_u32 s64, s63, s60
    s_add_u32 m0, s62, 98304
    s_nop 0
    buffer_load_dwordx4 v11, s[12:15], s63 offen lds
    s_add_u32 m0, s62, 99328
    s_nop 0
    buffer_load_dwordx4 v11, s[12:15], s64 offen lds
    s_add_u32 m0, s62, 114688
    s_nop 0
    buffer_load_dwordx4 v11, s[16:19], s63 offen lds
    s_add_u32 m0, s62, 115712
    s_nop 0
    buffer_load_dwordx4 v11, s[16:19], s64 offen lds
    v_dot2_f32_bf16 v19, v96, v96, v19
    v_dot2_f32_bf16 v18, v96, s67, v18
    v_dot2_f32_bf16 v23, v97, v97, v23
    v_dot2_f32_bf16 v22, v97, s67, v22
    v_dot2_f32_bf16 v19, v98, v98, v19
    v_dot2_f32_bf16 v18, v98, s67, v18
    v_dot2_f32_bf16 v23, v99, v99, v23
    v_dot2_f32_bf16 v22, v99, s67, v22
    v_dot2_f32_bf16 v19, v100, v100, v19
    v_dot2_f32_bf16 v18, v100, s67, v18
    v_dot2_f32_bf16 v23, v101, v101, v23
    v_dot2_f32_bf16 v22, v101, s67, v22
    v_dot2_f32_bf16 v19, v102, v102, v19
    v_dot2_f32_bf16 v18, v102, s67, v18
    v_dot2_f32_bf16 v23, v103, v103, v23
    v_dot2_f32_bf16 v22, v103, s67, v22
    v_dot2_f32_bf16 v19, v104, v104, v19
    v_dot2_f32_bf16 v18, v104, s67, v18
    v_dot2_f32_bf16 v23, v105, v105, v23
    v_dot2_f32_bf16 v22, v105, s67, v22
    v_dot2_f32_bf16 v19, v106, v106, v19
    v_dot2_f32_bf16 v18, v106, s67, v18
    v_dot2_f32_bf16 v23, v107, v107, v23
    v_dot2_f32_bf16 v22, v107, s67, v22
    v_dot2_f32_bf16 v19, v108, v108, v19
    v_dot2_f32_bf16 v18, v108, s67, v18
    v_dot2_f32_bf16 v23, v109, v109, v23
    v_dot2_f32_bf16 v22, v109, s67, v22
    v_dot2_f32_bf16 v19, v110, v110, v19
    v_dot2_f32_bf16 v18, v110, s67, v18
    v_dot2_f32_bf16 v23, v111, v111, v23
    v_dot2_f32_bf16 v22, v111, s67, v22
    v_dot2_f32_bf16 v19, v112, v112, v19
    v_dot2_f32_bf16 v18, v112, s67, v18
    v_dot2_f32_bf16 v23, v113, v113, v23
    v_dot2_f32_bf16 v22, v113, s67, v22
    v_dot2_f32_bf16 v19, v114, v114, v19
    v_dot2_f32_bf16 v18, v114, s67, v18
    v_dot2_f32_bf16 v23, v115, v115, v23
    v_dot2_f32_bf16 v22, v115, s67, v22
    v_dot2_f32_bf16 v19, v116, v116, v19
    v_dot2_f32_bf16 v18, v116, s67, v18
    v_dot2_f32_bf16 v23, v117, v117, v23
    v_dot2_f32_bf16 v22, v117, s67, v22
    v_dot2_f32_bf16 v19, v118, v118, v19
    v_dot2_f32_bf16 v18, v118, s67, v18
    v_dot2_f32_bf16 v23, v119, v119, v23
    v_dot2_f32_bf16 v22, v119, s67, v22
    v_dot2_f32_bf16 v19, v120, v120, v19
    v_dot2_f32_bf16 v18, v120, s67, v18
    v_dot2_f32_bf16 v23, v121, v121, v23
    v_dot2_f32_bf16 v22, v121, s67, v22
    v_dot2_f32_bf16 v19, v122, v122, v19
    v_dot2_f32_bf16 v18, v122, s67, v18
    v_dot2_f32_bf16 v23, v123, v123, v23
    v_dot2_f32_bf16 v22, v123, s67, v22
    v_dot2_f32_bf16 v19, v124, v124, v19
    v_dot2_f32_bf16 v18, v124, s67, v18
    v_dot2_f32_bf16 v23, v125, v125, v23
    v_dot2_f32_bf16 v22, v125, s67, v22
    v_dot2_f32_bf16 v19, v126, v126, v19
    v_dot2_f32_bf16 v18, v126, s67, v18
    v_dot2_f32_bf16 v23, v127, v127, v23
    v_dot2_f32_bf16 v22, v127, s67, v22
    s_nop 2
    v_add_f32 v16, v16, v20
    v_add_f32 v17, v17, v21
    v_add_f32 v18, v18, v22
    v_add_f32 v19, v19, v23
    s_nop 1
    v_add_f32_dpp v16, v16, v16 quad_perm:[1,0,3,2] row_mask:0xf bank_mask:0xf
    v_add_f32_dpp v17, v17, v17 quad_perm:[1,0,3,2] row_mask:0xf bank_mask:0xf
    v_add_f32_dpp v18, v18, v18 quad_perm:[1,0,3,2] row_mask:0xf bank_mask:0xf
    v_add_f32_dpp v19, v19, v19 quad_perm:[1,0,3,2] row_mask:0xf bank_mask:0xf
    s_nop 1
    v_add_f32_dpp v16, v16, v16 quad_perm:[2,3,0,1] row_mask:0xf bank_mask:0xf
    v_add_f32_dpp v17, v17, v17 quad_perm:[2,3,0,1] row_mask:0xf bank_mask:0xf
    v_add_f32_dpp v18, v18, v18 quad_perm:[2,3,0,1] row_mask:0xf bank_mask:0xf
    v_add_f32_dpp v19, v19, v19 quad_perm:[2,3,0,1] row_mask:0xf bank_mask:0xf
    s_nop 1
    v_add_f32_dpp v16, v16, v16 row_half_mirror row_mask:0xf bank_mask:0xf
    v_add_f32_dpp v17, v17, v17 row_half_mirror row_mask:0xf bank_mask:0xf
    v_add_f32_dpp v18, v18, v18 row_half_mirror row_mask:0xf bank_mask:0xf
    v_add_f32_dpp v19, v19, v19 row_half_mirror row_mask:0xf bank_mask:0xf
    s_nop 1
    s_mov_b32 s68, 0x3b000000
    s_mov_b32 s69, 0x3727c5ac
    v_mul_f32 v16, s68, v16
    v_mul_f32 v17, s68, v17
    v_fma_f32 v17, -v16, v16, v17
    v_max_f32 v17, 0, v17
    v_add_f32 v17, s69, v17
    v_rsq_f32 v56, v17
    s_nop 0
    v_sub_f32 v57, 0, v16
    v_mul_f32 v18, s68, v18
    v_mul_f32 v19, s68, v19
    v_fma_f32 v19, -v18, v18, v19
    v_max_f32 v19, 0, v19
    v_add_f32 v19, s69, v19
    v_rsq_f32 v58, v19
    s_nop 0
    v_sub_f32 v59, 0, v18
    v_and_b32 v2, 1, v1
    v_lshlrev_b32 v60, 4, v2
    v_mov_b32 v61, 0
    v_mov_b32 v2, 0x3f80
    v_lshlrev_b32 v2, v60, v2
    v_cndmask_b32 v16, v2, v61, s[22:23]
    v_cndmask_b32 v17, v61, v2, s[22:23]
    v_mov_b32 v48, v57
    v_mov_b32 v52, v59
    v_mov_b32 v49, v57
    v_mov_b32 v53, v59
    v_mov_b32 v50, v57
    v_mov_b32 v54, v59
    v_mov_b32 v51, v57
    v_mov_b32 v55, v59
    s_nop 1
    s_cmp_eq_u32 s56, 1
    s_cbranch_scc1 K1_NORM_DFT
    s_lshl_b32 s71, s7, 6
    s_add_u32 s71, s71, 131072
    v_lshl_add_u32 v2, v3, 2, s71
    ds_write_b32 v2, v56
    ds_write_b32 v2, v58 offset:32
    v_mfma_f32_4x4x4_16b_bf16 v[128:131], v[16:17], v[64:65], v[48:51]
    v_mfma_f32_4x4x4_16b_bf16 v[132:135], v[16:17], v[66:67], v[48:51]
    v_mfma_f32_4x4x4_16b_bf16 v[136:139], v[16:17], v[96:97], v[52:55]
    v_mfma_f32_4x4x4_16b_bf16 v[140:143], v[16:17], v[98:99], v[52:55]
    s_nop 4
    v_mfma_f32_4x4x4_16b_bf16 v[144:147], v[16:17], v[68:69], v[48:51]
    v_mfma_f32_4x4x4_16b_bf16 v[148:151], v[16:17], v[70:71], v[48:51]
    v_mfma_f32_4x4x4_16b_bf16 v[152:155], v[16:17], v[100:101], v[52:55]
    v_mfma_f32_4x4x4_16b_bf16 v[156:159], v[16:17], v[102:103], v[52:55]
    v_cvt_pk_bf16_f32 v64, v128, v129
    v_cvt_pk_bf16_f32 v65, v130, v131
    v_cvt_pk_bf16_f32 v66, v132, v133
    v_cvt_pk_bf16_f32 v67, v134, v135
    v_cvt_pk_bf16_f32 v96, v136, v137
    v_cvt_pk_bf16_f32 v97, v138, v139
    v_cvt_pk_bf16_f32 v98, v140, v141
    v_cvt_pk_bf16_f32 v99, v142, v143
    ds_write2_b64 v7, v[64:65], v[66:67] offset0:0 offset1:1
    ds_write2_b64 v8, v[96:97], v[98:99] offset0:0 offset1:1
    v_mfma_f32_4x4x4_16b_bf16 v[128:131], v[16:17], v[72:73], v[48:51]
    v_mfma_f32_4x4x4_16b_bf16 v[132:135], v[16:17], v[74:75], v[48:51]
    v_mfma_f32_4x4x4_16b_bf16 v[136:139], v[16:17], v[104:105], v[52:55]
    v_mfma_f32_4x4x4_16b_bf16 v[140:143], v[16:17], v[106:107], v[52:55]
    v_cvt_pk_bf16_f32 v68, v144, v145
    v_cvt_pk_bf16_f32 v69, v146, v147
    v_cvt_pk_bf16_f32 v70, v148, v149
    v_cvt_pk_bf16_f32 v71, v150, v151
    v_cvt_pk_bf16_f32 v100, v152, v153
    v_cvt_pk_bf16_f32 v101, v154, v155
    v_cvt_pk_bf16_f32 v102, v156, v157
    v_cvt_pk_bf16_f32 v103, v158, v159
    ds_write2_b64 v5, v[68:69], v[70:71] offset0:0 offset1:1
    ds_write2_b64 v6, v[100:101], v[102:103] offset0:0 offset1:1
    v_mfma_f32_4x4x4_16b_bf16 v[144:147], v[16:17], v[76:77], v[48:51]
    v_mfma_f32_4x4x4_16b_bf16 v[148:151], v[16:17], v[78:79], v[48:51]
    v_mfma_f32_4x4x4_16b_bf16 v[152:155], v[16:17], v[108:109], v[52:55]
    v_mfma_f32_4x4x4_16b_bf16 v[156:159], v[16:17], v[110:111], v[52:55]
    v_cvt_pk_bf16_f32 v72, v128, v129
    v_cvt_pk_bf16_f32 v73, v130, v131
    v_cvt_pk_bf16_f32 v74, v132, v133
    v_cvt_pk_bf16_f32 v75, v134, v135
    v_cvt_pk_bf16_f32 v104, v136, v137
    v_cvt_pk_bf16_f32 v105, v138, v139
    v_cvt_pk_bf16_f32 v106, v140, v141
    v_cvt_pk_bf16_f32 v107, v142, v143
    ds_write2_b64 v7, v[72:73], v[74:75] offset0:32 offset1:33
    ds_write2_b64 v8, v[104:105], v[106:107] offset0:32 offset1:33
    v_mfma_f32_4x4x4_16b_bf16 v[128:131], v[16:17], v[80:81], v[48:51]
    v_mfma_f32_4x4x4_16b_bf16 v[132:135], v[16:17], v[82:83], v[48:51]
    v_mfma_f32_4x4x4_16b_bf16 v[136:139], v[16:17], v[112:113], v[52:55]
    v_mfma_f32_4x4x4_16b_bf16 v[140:143], v[16:17], v[114:115], v[52:55]
    v_cvt_pk_bf16_f32 v76, v144, v145
    v_cvt_pk_bf16_f32 v77, v146, v147
    v_cvt_pk_bf16_f32 v78, v148, v149
    v_cvt_pk_bf16_f32 v79, v150, v151
    v_cvt_pk_bf16_f32 v108, v152, v153
    v_cvt_pk_bf16_f32 v109, v154, v155
    v_cvt_pk_bf16_f32 v110, v156, v157
    v_cvt_pk_bf16_f32 v111, v158, v159
    ds_write2_b64 v5, v[76:77], v[78:79] offset0:32 offset1:33
    ds_write2_b64 v6, v[108:109], v[110:111] offset0:32 offset1:33
    v_mfma_f32_4x4x4_16b_bf16 v[144:147], v[16:17], v[84:85], v[48:51]
    v_mfma_f32_4x4x4_16b_bf16 v[148:151], v[16:17], v[86:87], v[48:51]
    v_mfma_f32_4x4x4_16b_bf16 v[152:155], v[16:17], v[116:117], v[52:55]
    v_mfma_f32_4x4x4_16b_bf16 v[156:159], v[16:17], v[118:119], v[52:55]
    v_cvt_pk_bf16_f32 v80, v128, v129
    v_cvt_pk_bf16_f32 v81, v130, v131
    v_cvt_pk_bf16_f32 v82, v132, v133
    v_cvt_pk_bf16_f32 v83, v134, v135
    v_cvt_pk_bf16_f32 v112, v136, v137
    v_cvt_pk_bf16_f32 v113, v138, v139
    v_cvt_pk_bf16_f32 v114, v140, v141
    v_cvt_pk_bf16_f32 v115, v142, v143
    v_mfma_f32_4x4x4_16b_bf16 v[128:131], v[16:17], v[88:89], v[48:51]
    v_mfma_f32_4x4x4_16b_bf16 v[132:135], v[16:17], v[90:91], v[48:51]
    v_mfma_f32_4x4x4_16b_bf16 v[136:139], v[16:17], v[120:121], v[52:55]
    v_mfma_f32_4x4x4_16b_bf16 v[140:143], v[16:17], v[122:123], v[52:55]
    v_cvt_pk_bf16_f32 v84, v144, v145
    v_cvt_pk_bf16_f32 v85, v146, v147
    v_cvt_pk_bf16_f32 v86, v148, v149
    v_cvt_pk_bf16_f32 v87, v150, v151
    v_cvt_pk_bf16_f32 v116, v152, v153
    v_cvt_pk_bf16_f32 v117, v154, v155
    v_cvt_pk_bf16_f32 v118, v156, v157
    v_cvt_pk_bf16_f32 v119, v158, v159
    v_mfma_f32_4x4x4_16b_bf16 v[144:147], v[16:17], v[92:93], v[48:51]
    v_mfma_f32_4x4x4_16b_bf16 v[148:151], v[16:17], v[94:95], v[48:51]
    v_mfma_f32_4x4x4_16b_bf16 v[152:155], v[16:17], v[124:125], v[52:55]
    v_mfma_f32_4x4x4_16b_bf16 v[156:159], v[16:17], v[126:127], v[52:55]
    v_cvt_pk_bf16_f32 v88, v128, v129
    v_cvt_pk_bf16_f32 v89, v130, v131
    v_cvt_pk_bf16_f32 v90, v132, v133
    v_cvt_pk_bf16_f32 v91, v134, v135
    v_cvt_pk_bf16_f32 v120, v136, v137
    v_cvt_pk_bf16_f32 v121, v138, v139
    v_cvt_pk_bf16_f32 v122, v140, v141
    v_cvt_pk_bf16_f32 v123, v142, v143
    s_nop 4
    v_cvt_pk_bf16_f32 v92, v144, v145
    v_cvt_pk_bf16_f32 v93, v146, v147
    v_cvt_pk_bf16_f32 v94, v148, v149
    v_cvt_pk_bf16_f32 v95, v150, v151
    v_cvt_pk_bf16_f32 v124, v152, v153
    v_cvt_pk_bf16_f32 v125, v154, v155
    v_cvt_pk_bf16_f32 v126, v156, v157
    v_cvt_pk_bf16_f32 v127, v158, v159
    s_branch K1_NORM_DONE
K1_NORM_DFT:
    s_lshl_b32 s71, s5, 3
    s_add_u32 s71, s71, s7
    v_or_b32 v30, s71, v3
    v_cmp_eq_u32 vcc, 0, v30
    v_mov_b32 v62, 1.0
    v_mov_b32 v63, -1.0
    v_cndmask_b32 v30, v62, v61, vcc
    v_cndmask_b32 v31, v63, v62, vcc
    v_mov_b32 v20, v56
    v_mul_f32 v22, v30, v58
    v_mul_f32 v24, v30, v56
    v_mul_f32 v26, v31, v58
    v_mfma_f32_4x4x4_16b_bf16 v[128:131], v[16:17], v[64:65], v[48:51]
    v_mfma_f32_4x4x4_16b_bf16 v[132:135], v[16:17], v[66:67], v[48:51]
    v_mfma_f32_4x4x4_16b_bf16 v[136:139], v[16:17], v[96:97], v[52:55]
    v_mfma_f32_4x4x4_16b_bf16 v[140:143], v[16:17], v[98:99], v[52:55]
    s_nop 4
    v_mfma_f32_4x4x4_16b_bf16 v[144:147], v[16:17], v[68:69], v[48:51]
    v_mfma_f32_4x4x4_16b_bf16 v[148:151], v[16:17], v[70:71], v[48:51]
    v_mfma_f32_4x4x4_16b_bf16 v[152:155], v[16:17], v[100:101], v[52:55]
    v_mfma_f32_4x4x4_16b_bf16 v[156:159], v[16:17], v[102:103], v[52:55]
    v_pk_mul_f32 v[32:33], v[128:129], v[20:21] op_sel_hi:[1,0]
    v_pk_mul_f32 v[34:35], v[128:129], v[24:25] op_sel_hi:[1,0]
    v_pk_fma_f32 v[32:33], v[136:137], v[22:23], v[32:33] op_sel_hi:[1,0,1]
    v_pk_fma_f32 v[34:35], v[136:137], v[26:27], v[34:35] op_sel_hi:[1,0,1]
    v_cvt_pk_bf16_f32 v64, v32, v33
    v_cvt_pk_bf16_f32 v96, v34, v35
    v_pk_mul_f32 v[32:33], v[130:131], v[20:21] op_sel_hi:[1,0]
    v_pk_mul_f32 v[34:35], v[130:131], v[24:25] op_sel_hi:[1,0]
    v_pk_fma_f32 v[32:33], v[138:139], v[22:23], v[32:33] op_sel_hi:[1,0,1]
    v_pk_fma_f32 v[34:35], v[138:139], v[26:27], v[34:35] op_sel_hi:[1,0,1]
    v_cvt_pk_bf16_f32 v65, v32, v33
    v_cvt_pk_bf16_f32 v97, v34, v35
    v_pk_mul_f32 v[32:33], v[132:133], v[20:21] op_sel_hi:[1,0]
    v_pk_mul_f32 v[34:35], v[132:133], v[24:25] op_sel_hi:[1,0]
    v_pk_fma_f32 v[32:33], v[140:141], v[22:23], v[32:33] op_sel_hi:[1,0,1]
    v_pk_fma_f32 v[34:35], v[140:141], v[26:27], v[34:35] op_sel_hi:[1,0,1]
    v_cvt_pk_bf16_f32 v66, v32, v33
    v_cvt_pk_bf16_f32 v98, v34, v35
    v_pk_mul_f32 v[32:33], v[134:135], v[20:21] op_sel_hi:[1,0]
    v_pk_mul_f32 v[34:35], v[134:135], v[24:25] op_sel_hi:[1,0]
    v_pk_fma_f32 v[32:33], v[142:143], v[22:23], v[32:33] op_sel_hi:[1,0,1]
    v_pk_fma_f32 v[34:35], v[142:143], v[26:27], v[34:35] op_sel_hi:[1,0,1]
    v_cvt_pk_bf16_f32 v67, v32, v33
    v_cvt_pk_bf16_f32 v99, v34, v35
    ds_write2_b64 v7, v[64:65], v[66:67] offset0:0 offset1:1
    ds_write2_b64 v8, v[96:97], v[98:99] offset0:0 offset1:1
    v_mfma_f32_4x4x4_16b_bf16 v[128:131], v[16:17], v[72:73], v[48:51]
    v_mfma_f32_4x4x4_16b_bf16 v[132:135], v[16:17], v[74:75], v[48:51]
    v_mfma_f32_4x4x4_16b_bf16 v[136:139], v[16:17], v[104:105], v[52:55]
    v_mfma_f32_4x4x4_16b_bf16 v[140:143], v[16:17], v[106:107], v[52:55]
    v_pk_mul_f32 v[32:33], v[144:145], v[20:21] op_sel_hi:[1,0]
    v_pk_mul_f32 v[34:35], v[144:145], v[24:25] op_sel_hi:[1,0]
    v_pk_fma_f32 v[32:33], v[152:153], v[22:23], v[32:33] op_sel_hi:[1,0,1]
    v_pk_fma_f32 v[34:35], v[152:153], v[26:27], v[34:35] op_sel_hi:[1,0,1]
    v_cvt_pk_bf16_f32 v68, v32, v33
    v_cvt_pk_bf16_f32 v100, v34, v35
    v_pk_mul_f32 v[32:33], v[146:147], v[20:21] op_sel_hi:[1,0]
    v_pk_mul_f32 v[34:35], v[146:147], v[24:25] op_sel_hi:[1,0]
    v_pk_fma_f32 v[32:33], v[154:155], v[22:23], v[32:33] op_sel_hi:[1,0,1]
    v_pk_fma_f32 v[34:35], v[154:155], v[26:27], v[34:35] op_sel_hi:[1,0,1]
    v_cvt_pk_bf16_f32 v69, v32, v33
    v_cvt_pk_bf16_f32 v101, v34, v35
    v_pk_mul_f32 v[32:33], v[148:149], v[20:21] op_sel_hi:[1,0]
    v_pk_mul_f32 v[34:35], v[148:149], v[24:25] op_sel_hi:[1,0]
    v_pk_fma_f32 v[32:33], v[156:157], v[22:23], v[32:33] op_sel_hi:[1,0,1]
    v_pk_fma_f32 v[34:35], v[156:157], v[26:27], v[34:35] op_sel_hi:[1,0,1]
    v_cvt_pk_bf16_f32 v70, v32, v33
    v_cvt_pk_bf16_f32 v102, v34, v35
    v_pk_mul_f32 v[32:33], v[150:151], v[20:21] op_sel_hi:[1,0]
    v_pk_mul_f32 v[34:35], v[150:151], v[24:25] op_sel_hi:[1,0]
    v_pk_fma_f32 v[32:33], v[158:159], v[22:23], v[32:33] op_sel_hi:[1,0,1]
    v_pk_fma_f32 v[34:35], v[158:159], v[26:27], v[34:35] op_sel_hi:[1,0,1]
    v_cvt_pk_bf16_f32 v71, v32, v33
    v_cvt_pk_bf16_f32 v103, v34, v35
    ds_write2_b64 v5, v[68:69], v[70:71] offset0:0 offset1:1
    ds_write2_b64 v6, v[100:101], v[102:103] offset0:0 offset1:1
    v_mfma_f32_4x4x4_16b_bf16 v[144:147], v[16:17], v[76:77], v[48:51]
    v_mfma_f32_4x4x4_16b_bf16 v[148:151], v[16:17], v[78:79], v[48:51]
    v_mfma_f32_4x4x4_16b_bf16 v[152:155], v[16:17], v[108:109], v[52:55]
    v_mfma_f32_4x4x4_16b_bf16 v[156:159], v[16:17], v[110:111], v[52:55]
    v_pk_mul_f32 v[32:33], v[128:129], v[20:21] op_sel_hi:[1,0]
    v_pk_mul_f32 v[34:35], v[128:129], v[24:25] op_sel_hi:[1,0]
    v_pk_fma_f32 v[32:33], v[136:137], v[22:23], v[32:33] op_sel_hi:[1,0,1]
    v_pk_fma_f32 v[34:35], v[136:137], v[26:27], v[34:35] op_sel_hi:[1,0,1]
    v_cvt_pk_bf16_f32 v72, v32, v33
    v_cvt_pk_bf16_f32 v104, v34, v35
    v_pk_mul_f32 v[32:33], v[130:131], v[20:21] op_sel_hi:[1,0]
    v_pk_mul_f32 v[34:35], v[130:131], v[24:25] op_sel_hi:[1,0]
    v_pk_fma_f32 v[32:33], v[138:139], v[22:23], v[32:33] op_sel_hi:[1,0,1]
    v_pk_fma_f32 v[34:35], v[138:139], v[26:27], v[34:35] op_sel_hi:[1,0,1]
    v_cvt_pk_bf16_f32 v73, v32, v33
    v_cvt_pk_bf16_f32 v105, v34, v35
    v_pk_mul_f32 v[32:33], v[132:133], v[20:21] op_sel_hi:[1,0]
    v_pk_mul_f32 v[34:35], v[132:133], v[24:25] op_sel_hi:[1,0]
    v_pk_fma_f32 v[32:33], v[140:141], v[22:23], v[32:33] op_sel_hi:[1,0,1]
    v_pk_fma_f32 v[34:35], v[140:141], v[26:27], v[34:35] op_sel_hi:[1,0,1]
    v_cvt_pk_bf16_f32 v74, v32, v33
    v_cvt_pk_bf16_f32 v106, v34, v35
    v_pk_mul_f32 v[32:33], v[134:135], v[20:21] op_sel_hi:[1,0]
    v_pk_mul_f32 v[34:35], v[134:135], v[24:25] op_sel_hi:[1,0]
    v_pk_fma_f32 v[32:33], v[142:143], v[22:23], v[32:33] op_sel_hi:[1,0,1]
    v_pk_fma_f32 v[34:35], v[142:143], v[26:27], v[34:35] op_sel_hi:[1,0,1]
    v_cvt_pk_bf16_f32 v75, v32, v33
    v_cvt_pk_bf16_f32 v107, v34, v35
    ds_write2_b64 v7, v[72:73], v[74:75] offset0:32 offset1:33
    ds_write2_b64 v8, v[104:105], v[106:107] offset0:32 offset1:33
    v_mfma_f32_4x4x4_16b_bf16 v[128:131], v[16:17], v[80:81], v[48:51]
    v_mfma_f32_4x4x4_16b_bf16 v[132:135], v[16:17], v[82:83], v[48:51]
    v_mfma_f32_4x4x4_16b_bf16 v[136:139], v[16:17], v[112:113], v[52:55]
    v_mfma_f32_4x4x4_16b_bf16 v[140:143], v[16:17], v[114:115], v[52:55]
    v_pk_mul_f32 v[32:33], v[144:145], v[20:21] op_sel_hi:[1,0]
    v_pk_mul_f32 v[34:35], v[144:145], v[24:25] op_sel_hi:[1,0]
    v_pk_fma_f32 v[32:33], v[152:153], v[22:23], v[32:33] op_sel_hi:[1,0,1]
    v_pk_fma_f32 v[34:35], v[152:153], v[26:27], v[34:35] op_sel_hi:[1,0,1]
    v_cvt_pk_bf16_f32 v76, v32, v33
    v_cvt_pk_bf16_f32 v108, v34, v35
    v_pk_mul_f32 v[32:33], v[146:147], v[20:21] op_sel_hi:[1,0]
    v_pk_mul_f32 v[34:35], v[146:147], v[24:25] op_sel_hi:[1,0]
    v_pk_fma_f32 v[32:33], v[154:155], v[22:23], v[32:33] op_sel_hi:[1,0,1]
    v_pk_fma_f32 v[34:35], v[154:155], v[26:27], v[34:35] op_sel_hi:[1,0,1]
    v_cvt_pk_bf16_f32 v77, v32, v33
    v_cvt_pk_bf16_f32 v109, v34, v35
    v_pk_mul_f32 v[32:33], v[148:149], v[20:21] op_sel_hi:[1,0]
    v_pk_mul_f32 v[34:35], v[148:149], v[24:25] op_sel_hi:[1,0]
    v_pk_fma_f32 v[32:33], v[156:157], v[22:23], v[32:33] op_sel_hi:[1,0,1]
    v_pk_fma_f32 v[34:35], v[156:157], v[26:27], v[34:35] op_sel_hi:[1,0,1]
    v_cvt_pk_bf16_f32 v78, v32, v33
    v_cvt_pk_bf16_f32 v110, v34, v35
    v_pk_mul_f32 v[32:33], v[150:151], v[20:21] op_sel_hi:[1,0]
    v_pk_mul_f32 v[34:35], v[150:151], v[24:25] op_sel_hi:[1,0]
    v_pk_fma_f32 v[32:33], v[158:159], v[22:23], v[32:33] op_sel_hi:[1,0,1]
    v_pk_fma_f32 v[34:35], v[158:159], v[26:27], v[34:35] op_sel_hi:[1,0,1]
    v_cvt_pk_bf16_f32 v79, v32, v33
    v_cvt_pk_bf16_f32 v111, v34, v35
    ds_write2_b64 v5, v[76:77], v[78:79] offset0:32 offset1:33
    ds_write2_b64 v6, v[108:109], v[110:111] offset0:32 offset1:33
    v_mfma_f32_4x4x4_16b_bf16 v[144:147], v[16:17], v[84:85], v[48:51]
    v_mfma_f32_4x4x4_16b_bf16 v[148:151], v[16:17], v[86:87], v[48:51]
    v_mfma_f32_4x4x4_16b_bf16 v[152:155], v[16:17], v[116:117], v[52:55]
    v_mfma_f32_4x4x4_16b_bf16 v[156:159], v[16:17], v[118:119], v[52:55]
    v_pk_mul_f32 v[32:33], v[128:129], v[20:21] op_sel_hi:[1,0]
    v_pk_mul_f32 v[34:35], v[128:129], v[24:25] op_sel_hi:[1,0]
    v_pk_fma_f32 v[32:33], v[136:137], v[22:23], v[32:33] op_sel_hi:[1,0,1]
    v_pk_fma_f32 v[34:35], v[136:137], v[26:27], v[34:35] op_sel_hi:[1,0,1]
    v_cvt_pk_bf16_f32 v80, v32, v33
    v_cvt_pk_bf16_f32 v112, v34, v35
    v_pk_mul_f32 v[32:33], v[130:131], v[20:21] op_sel_hi:[1,0]
    v_pk_mul_f32 v[34:35], v[130:131], v[24:25] op_sel_hi:[1,0]
    v_pk_fma_f32 v[32:33], v[138:139], v[22:23], v[32:33] op_sel_hi:[1,0,1]
    v_pk_fma_f32 v[34:35], v[138:139], v[26:27], v[34:35] op_sel_hi:[1,0,1]
    v_cvt_pk_bf16_f32 v81, v32, v33
    v_cvt_pk_bf16_f32 v113, v34, v35
    v_pk_mul_f32 v[32:33], v[132:133], v[20:21] op_sel_hi:[1,0]
    v_pk_mul_f32 v[34:35], v[132:133], v[24:25] op_sel_hi:[1,0]
    v_pk_fma_f32 v[32:33], v[140:141], v[22:23], v[32:33] op_sel_hi:[1,0,1]
    v_pk_fma_f32 v[34:35], v[140:141], v[26:27], v[34:35] op_sel_hi:[1,0,1]
    v_cvt_pk_bf16_f32 v82, v32, v33
    v_cvt_pk_bf16_f32 v114, v34, v35
    v_pk_mul_f32 v[32:33], v[134:135], v[20:21] op_sel_hi:[1,0]
    v_pk_mul_f32 v[34:35], v[134:135], v[24:25] op_sel_hi:[1,0]
    v_pk_fma_f32 v[32:33], v[142:143], v[22:23], v[32:33] op_sel_hi:[1,0,1]
    v_pk_fma_f32 v[34:35], v[142:143], v[26:27], v[34:35] op_sel_hi:[1,0,1]
    v_cvt_pk_bf16_f32 v83, v32, v33
    v_cvt_pk_bf16_f32 v115, v34, v35
    v_mfma_f32_4x4x4_16b_bf16 v[128:131], v[16:17], v[88:89], v[48:51]
    v_mfma_f32_4x4x4_16b_bf16 v[132:135], v[16:17], v[90:91], v[48:51]
    v_mfma_f32_4x4x4_16b_bf16 v[136:139], v[16:17], v[120:121], v[52:55]
    v_mfma_f32_4x4x4_16b_bf16 v[140:143], v[16:17], v[122:123], v[52:55]
    v_pk_mul_f32 v[32:33], v[144:145], v[20:21] op_sel_hi:[1,0]
    v_pk_mul_f32 v[34:35], v[144:145], v[24:25] op_sel_hi:[1,0]
    v_pk_fma_f32 v[32:33], v[152:153], v[22:23], v[32:33] op_sel_hi:[1,0,1]
    v_pk_fma_f32 v[34:35], v[152:153], v[26:27], v[34:35] op_sel_hi:[1,0,1]
    v_cvt_pk_bf16_f32 v84, v32, v33
    v_cvt_pk_bf16_f32 v116, v34, v35
    v_pk_mul_f32 v[32:33], v[146:147], v[20:21] op_sel_hi:[1,0]
    v_pk_mul_f32 v[34:35], v[146:147], v[24:25] op_sel_hi:[1,0]
    v_pk_fma_f32 v[32:33], v[154:155], v[22:23], v[32:33] op_sel_hi:[1,0,1]
    v_pk_fma_f32 v[34:35], v[154:155], v[26:27], v[34:35] op_sel_hi:[1,0,1]
    v_cvt_pk_bf16_f32 v85, v32, v33
    v_cvt_pk_bf16_f32 v117, v34, v35
    v_pk_mul_f32 v[32:33], v[148:149], v[20:21] op_sel_hi:[1,0]
    v_pk_mul_f32 v[34:35], v[148:149], v[24:25] op_sel_hi:[1,0]
    v_pk_fma_f32 v[32:33], v[156:157], v[22:23], v[32:33] op_sel_hi:[1,0,1]
    v_pk_fma_f32 v[34:35], v[156:157], v[26:27], v[34:35] op_sel_hi:[1,0,1]
    v_cvt_pk_bf16_f32 v86, v32, v33
    v_cvt_pk_bf16_f32 v118, v34, v35
    v_pk_mul_f32 v[32:33], v[150:151], v[20:21] op_sel_hi:[1,0]
    v_pk_mul_f32 v[34:35], v[150:151], v[24:25] op_sel_hi:[1,0]
    v_pk_fma_f32 v[32:33], v[158:159], v[22:23], v[32:33] op_sel_hi:[1,0,1]
    v_pk_fma_f32 v[34:35], v[158:159], v[26:27], v[34:35] op_sel_hi:[1,0,1]
    v_cvt_pk_bf16_f32 v87, v32, v33
    v_cvt_pk_bf16_f32 v119, v34, v35
    v_mfma_f32_4x4x4_16b_bf16 v[144:147], v[16:17], v[92:93], v[48:51]
    v_mfma_f32_4x4x4_16b_bf16 v[148:151], v[16:17], v[94:95], v[48:51]
    v_mfma_f32_4x4x4_16b_bf16 v[152:155], v[16:17], v[124:125], v[52:55]
    v_mfma_f32_4x4x4_16b_bf16 v[156:159], v[16:17], v[126:127], v[52:55]
    v_pk_mul_f32 v[32:33], v[128:129], v[20:21] op_sel_hi:[1,0]
    v_pk_mul_f32 v[34:35], v[128:129], v[24:25] op_sel_hi:[1,0]
    v_pk_fma_f32 v[32:33], v[136:137], v[22:23], v[32:33] op_sel_hi:[1,0,1]
    v_pk_fma_f32 v[34:35], v[136:137], v[26:27], v[34:35] op_sel_hi:[1,0,1]
    v_cvt_pk_bf16_f32 v88, v32, v33
    v_cvt_pk_bf16_f32 v120, v34, v35
    v_pk_mul_f32 v[32:33], v[130:131], v[20:21] op_sel_hi:[1,0]
    v_pk_mul_f32 v[34:35], v[130:131], v[24:25] op_sel_hi:[1,0]
    v_pk_fma_f32 v[32:33], v[138:139], v[22:23], v[32:33] op_sel_hi:[1,0,1]
    v_pk_fma_f32 v[34:35], v[138:139], v[26:27], v[34:35] op_sel_hi:[1,0,1]
    v_cvt_pk_bf16_f32 v89, v32, v33
    v_cvt_pk_bf16_f32 v121, v34, v35
    v_pk_mul_f32 v[32:33], v[132:133], v[20:21] op_sel_hi:[1,0]
    v_pk_mul_f32 v[34:35], v[132:133], v[24:25] op_sel_hi:[1,0]
    v_pk_fma_f32 v[32:33], v[140:141], v[22:23], v[32:33] op_sel_hi:[1,0,1]
    v_pk_fma_f32 v[34:35], v[140:141], v[26:27], v[34:35] op_sel_hi:[1,0,1]
    v_cvt_pk_bf16_f32 v90, v32, v33
    v_cvt_pk_bf16_f32 v122, v34, v35
    v_pk_mul_f32 v[32:33], v[134:135], v[20:21] op_sel_hi:[1,0]
    v_pk_mul_f32 v[34:35], v[134:135], v[24:25] op_sel_hi:[1,0]
    v_pk_fma_f32 v[32:33], v[142:143], v[22:23], v[32:33] op_sel_hi:[1,0,1]
    v_pk_fma_f32 v[34:35], v[142:143], v[26:27], v[34:35] op_sel_hi:[1,0,1]
    v_cvt_pk_bf16_f32 v91, v32, v33
    v_cvt_pk_bf16_f32 v123, v34, v35
    s_nop 4
    v_pk_mul_f32 v[32:33], v[144:145], v[20:21] op_sel_hi:[1,0]
    v_pk_mul_f32 v[34:35], v[144:145], v[24:25] op_sel_hi:[1,0]
    v_pk_fma_f32 v[32:33], v[152:153], v[22:23], v[32:33] op_sel_hi:[1,0,1]
    v_pk_fma_f32 v[34:35], v[152:153], v[26:27], v[34:35] op_sel_hi:[1,0,1]
    v_cvt_pk_bf16_f32 v92, v32, v33
    v_cvt_pk_bf16_f32 v124, v34, v35
    v_pk_mul_f32 v[32:33], v[146:147], v[20:21] op_sel_hi:[1,0]
    v_pk_mul_f32 v[34:35], v[146:147], v[24:25] op_sel_hi:[1,0]
    v_pk_fma_f32 v[32:33], v[154:155], v[22:23], v[32:33] op_sel_hi:[1,0,1]
    v_pk_fma_f32 v[34:35], v[154:155], v[26:27], v[34:35] op_sel_hi:[1,0,1]
    v_cvt_pk_bf16_f32 v93, v32, v33
    v_cvt_pk_bf16_f32 v125, v34, v35
    v_pk_mul_f32 v[32:33], v[148:149], v[20:21] op_sel_hi:[1,0]
    v_pk_mul_f32 v[34:35], v[148:149], v[24:25] op_sel_hi:[1,0]
    v_pk_fma_f32 v[32:33], v[156:157], v[22:23], v[32:33] op_sel_hi:[1,0,1]
    v_pk_fma_f32 v[34:35], v[156:157], v[26:27], v[34:35] op_sel_hi:[1,0,1]
    v_cvt_pk_bf16_f32 v94, v32, v33
    v_cvt_pk_bf16_f32 v126, v34, v35
    v_pk_mul_f32 v[32:33], v[150:151], v[20:21] op_sel_hi:[1,0]
    v_pk_mul_f32 v[34:35], v[150:151], v[24:25] op_sel_hi:[1,0]
    v_pk_fma_f32 v[32:33], v[158:159], v[22:23], v[32:33] op_sel_hi:[1,0,1]
    v_pk_fma_f32 v[34:35], v[158:159], v[26:27], v[34:35] op_sel_hi:[1,0,1]
    v_cvt_pk_bf16_f32 v95, v32, v33
    v_cvt_pk_bf16_f32 v127, v34, v35
K1_NORM_DONE:
    v_lshlrev_b32 v14, 4, v1
    s_and_b32 s72, s7, 3
    s_lshr_b32 s73, s7, 2
    s_lshl_b32 s20, s72, 5
    v_add_u32 v15, s20, v12
    v_and_b32 v16, 15, v15
    v_xor_b32 v16, v16, v13
    v_lshlrev_b32 v16, 4, v16
    v_lshl_add_u32 v15, v15, 9, v16
    v_xor_b32 v16, 0, v15
    v_xor_b32 v17, 32, v15
    v_xor_b32 v18, 64, v15
    v_xor_b32 v19, 96, v15
    v_xor_b32 v20, 128, v15
    v_xor_b32 v21, 160, v15
    v_xor_b32 v22, 192, v15
    v_xor_b32 v23, 224, v15
    s_waitcnt lgkmcnt(0)
    s_barrier
    ds_read_b128 v[128:131], v16 offset:0
    ds_read_b128 v[132:135], v17 offset:0
    ds_read_b128 v[136:139], v18 offset:0
    ds_read_b128 v[140:143], v19 offset:0
    ds_read_b128 v[144:147], v20 offset:0
    ds_read_b128 v[148:151], v21 offset:0
    ds_read_b128 v[152:155], v22 offset:0
    ds_read_b128 v[156:159], v23 offset:0
    ds_read_b128 v[160:163], v16 offset:256
    ds_read_b128 v[164:167], v17 offset:256
    ds_read_b128 v[168:171], v18 offset:256
    ds_read_b128 v[172:175], v19 offset:256
    ds_read_b128 v[176:179], v20 offset:256
    ds_read_b128 v[180:183], v21 offset:256
    ds_read_b128 v[184:187], v22 offset:256
    ds_read_b128 v[188:191], v23 offset:256
    s_lshl_b32 s20, s72, 7
    s_add_u32 s20, s20, 131072
    v_lshl_add_u32 v2, v12, 2, s20
    ds_read_b32 v15, v2
    v_lshrrev_b32 v24, 4, v1
    v_and_b32 v25, 15, v1
    v_lshrrev_b32 v26, 2, v25
    v_lshrrev_b32 v27, 1, v24
    v_lshl_add_u32 v27, v27, 3, v26
    v_lshlrev_b32 v27, 8, v27
    s_lshl_b32 s20, s73, 1
    v_xor_b32 v26, s20, v26
    v_lshl_add_u32 v27, v26, 6, v27
    v_and_b32 v24, 1, v24
    v_lshl_add_u32 v27, v24, 5, v27
    v_and_b32 v25, 3, v25
    v_lshl_add_u32 v27, v25, 3, v27
    v_xor_b32 v28, 64, v27
    s_or_b32 s20, s58, s73
    v_or_b32 v29, s20, v12
    v_cmp_eq_u32 vcc, 0, v29
    v_mov_b32 v30, 0
    v_bfrev_b32 v31, 1
    v_cndmask_b32 v29, v30, v31, vcc
    s_mov_b32 s24, s52
    s_and_b32 s25, s53, 0xffff
    s_mov_b32 s26, 0x1c0000
    s_mov_b32 s27, 0x20000
    s_min_u32 s28, s2, 223
    s_mul_i32 s29, s28, 4682
    s_lshr_b32 s29, s29, 16
    s_mul_i32 s30, s29, 14
    s_sub_u32 s30, s28, s30
    s_lshl_b32 s30, s30, 3
    s_add_u32 s30, s30, s7
    s_lshr_b32 s31, s29, 1
    s_lshl_b32 s31, s31, 5
    v_add_u32 v24, s31, v12
    s_and_b32 s31, s29, 1
    s_cmp_eq_u32 s31, 0
    s_cbranch_scc1 K1_WD_A
    v_sub_u32 v24, 0x200, v24
    v_cmp_eq_u32 vcc, 0x200, v24
    v_mov_b32 v25, 0x100
    s_nop 0
    v_cndmask_b32 v24, v24, v25, vcc
K1_WD_A:
    v_lshlrev_b32 v24, 1, v24
    v_lshl_add_u32 v24, v13, 12, v24
    s_lshl_b32 s30, s30, 14
    s_add_u32 s31, s30, 8192
    s_lshl_b32 s66, s28, 3
    s_add_u32 s66, s66, s7
    s_lshl_b32 s66, s66, 10
    s_add_u32 s66, s66, 7340032
    s_waitcnt vmcnt(4)
    s_waitcnt lgkmcnt(0)
    s_barrier
    s_mul_i32 s63, s61, 2
    s_add_u32 s64, s63, s60
    s_add_u32 m0, s62, 131072
    s_nop 0
    buffer_load_dwordx4 v11, s[12:15], s63 offen lds
    s_add_u32 m0, s62, 132096
    s_nop 0
    buffer_load_dwordx4 v11, s[12:15], s64 offen lds
    s_add_u32 m0, s62, 147456
    s_nop 0
    buffer_load_dwordx4 v11, s[16:19], s63 offen lds
    s_add_u32 m0, s62, 148480
    s_nop 0
    buffer_load_dwordx4 v11, s[16:19], s64 offen lds
    s_cmp_eq_u32 s56, 1
    s_cbranch_scc1 K1_MAIN_DFT
    v_add_u32 v2, 65536, v27
    v_add_u32 v3, 65536, v28
    ds_read_b64_tr_b16 v[32:33], v2 offset:0
    ds_read_b64_tr_b16 v[34:35], v2 offset:1024
    ds_read_b64_tr_b16 v[36:37], v3 offset:0
    ds_read_b64_tr_b16 v[38:39], v3 offset:1024
    ds_read_b64_tr_b16 v[40:41], v2 offset:16384
    ds_read_b64_tr_b16 v[42:43], v2 offset:17408
    ds_read_b64_tr_b16 v[44:45], v3 offset:16384
    ds_read_b64_tr_b16 v[46:47], v3 offset:17408
    ds_write2_b64 v7, v[80:81], v[82:83] offset0:0 offset1:1
    ds_write2_b64 v8, v[112:113], v[114:115] offset0:0 offset1:1
    ds_write2_b64 v5, v[84:85], v[86:87] offset0:0 offset1:1
    ds_write2_b64 v6, v[116:117], v[118:119] offset0:0 offset1:1
    ds_write2_b64 v7, v[88:89], v[90:91] offset0:32 offset1:33
    ds_write2_b64 v8, v[120:121], v[122:123] offset0:32 offset1:33
    ds_write2_b64 v5, v[92:93], v[94:95] offset0:32 offset1:33
    ds_write2_b64 v6, v[124:125], v[126:127] offset0:32 offset1:33
    s_waitcnt lgkmcnt(8)
    ds_read_b64_tr_b16 v[48:49], v2 offset:4096
    ds_read_b64_tr_b16 v[50:51], v2 offset:5120
    ds_read_b64_tr_b16 v[52:53], v3 offset:4096
    ds_read_b64_tr_b16 v[54:55], v3 offset:5120
    ds_read_b64_tr_b16 v[56:57], v2 offset:20480
    ds_read_b64_tr_b16 v[58:59], v2 offset:21504
    ds_read_b64_tr_b16 v[60:61], v3 offset:20480
    ds_read_b64_tr_b16 v[62:63], v3 offset:21504
    v_mfma_f32_32x32x16_bf16 v[64:79], v[32:35], v[128:131], 0
    v_mfma_f32_32x32x16_bf16 v[80:95], v[36:39], v[128:131], 0
    v_mfma_f32_32x32x16_bf16 v[96:111], v[40:43], v[128:131], 0
    v_mfma_f32_32x32x16_bf16 v[112:127], v[44:47], v[128:131], 0
    s_waitcnt lgkmcnt(0)
    ds_read_b64_tr_b16 v[32:33], v2 offset:8192
    ds_read_b64_tr_b16 v[34:35], v2 offset:9216
    ds_read_b64_tr_b16 v[36:37], v3 offset:8192
    ds_read_b64_tr_b16 v[38:39], v3 offset:9216
    ds_read_b64_tr_b16 v[40:41], v2 offset:24576
    ds_read_b64_tr_b16 v[42:43], v2 offset:25600
    ds_read_b64_tr_b16 v[44:45], v3 offset:24576
    ds_read_b64_tr_b16 v[46:47], v3 offset:25600
    v_mfma_f32_32x32x16_bf16 v[64:79], v[48:51], v[132:135], v[64:79]
    v_mfma_f32_32x32x16_bf16 v[80:95], v[52:55], v[132:135], v[80:95]
    v_mfma_f32_32x32x16_bf16 v[96:111], v[56:59], v[132:135], v[96:111]
    v_mfma_f32_32x32x16_bf16 v[112:127], v[60:63], v[132:135], v[112:127]
    s_waitcnt lgkmcnt(0)
    ds_read_b64_tr_b16 v[48:49], v2 offset:12288
    ds_read_b64_tr_b16 v[50:51], v2 offset:13312
    ds_read_b64_tr_b16 v[52:53], v3 offset:12288
    ds_read_b64_tr_b16 v[54:55], v3 offset:13312
    ds_read_b64_tr_b16 v[56:57], v2 offset:28672
    ds_read_b64_tr_b16 v[58:59], v2 offset:29696
    ds_read_b64_tr_b16 v[60:61], v3 offset:28672
    ds_read_b64_tr_b16 v[62:63], v3 offset:29696
    v_mfma_f32_32x32x16_bf16 v[64:79], v[32:35], v[136:139], v[64:79]
    v_mfma_f32_32x32x16_bf16 v[80:95], v[36:39], v[136:139], v[80:95]
    v_mfma_f32_32x32x16_bf16 v[96:111], v[40:43], v[136:139], v[96:111]
    v_mfma_f32_32x32x16_bf16 v[112:127], v[44:47], v[136:139], v[112:127]
    s_waitcnt lgkmcnt(0)
    s_waitcnt vmcnt(4)
    s_barrier
    v_add_u32 v2, 98304, v27
    v_add_u32 v3, 98304, v28
    ds_read_b64_tr_b16 v[32:33], v2 offset:0
    ds_read_b64_tr_b16 v[34:35], v2 offset:1024
    ds_read_b64_tr_b16 v[36:37], v3 offset:0
    ds_read_b64_tr_b16 v[38:39], v3 offset:1024
    ds_read_b64_tr_b16 v[40:41], v2 offset:16384
    ds_read_b64_tr_b16 v[42:43], v2 offset:17408
    ds_read_b64_tr_b16 v[44:45], v3 offset:16384
    ds_read_b64_tr_b16 v[46:47], v3 offset:17408
    ds_read_b128 v[192:195], v16 offset:0
    ds_read_b128 v[196:199], v17 offset:0
    ds_read_b128 v[200:203], v18 offset:0
    ds_read_b128 v[204:207], v19 offset:0
    s_mul_i32 s63, s61, 3
    s_add_u32 m0, s62, 65536
    s_nop 0
    buffer_load_dwordx4 v11, s[12:15], s63 offen lds
    s_mul_i32 s63, s61, 3
    s_add_u32 s63, s63, s60
    s_add_u32 m0, s62, 66560
    s_nop 0
    buffer_load_dwordx4 v11, s[12:15], s63 offen lds
    v_mfma_f32_32x32x16_bf16 v[64:79], v[48:51], v[140:143], v[64:79]
    v_mfma_f32_32x32x16_bf16 v[80:95], v[52:55], v[140:143], v[80:95]
    v_mfma_f32_32x32x16_bf16 v[96:111], v[56:59], v[140:143], v[96:111]
    v_mfma_f32_32x32x16_bf16 v[112:127], v[60:63], v[140:143], v[112:127]
    s_waitcnt lgkmcnt(4)
    ds_read_b64_tr_b16 v[48:49], v2 offset:4096
    ds_read_b64_tr_b16 v[50:51], v2 offset:5120
    ds_read_b64_tr_b16 v[52:53], v3 offset:4096
    ds_read_b64_tr_b16 v[54:55], v3 offset:5120
    ds_read_b64_tr_b16 v[56:57], v2 offset:20480
    ds_read_b64_tr_b16 v[58:59], v2 offset:21504
    ds_read_b64_tr_b16 v[60:61], v3 offset:20480
    ds_read_b64_tr_b16 v[62:63], v3 offset:21504
    ds_read_b128 v[208:211], v20 offset:0
    ds_read_b128 v[212:215], v21 offset:0
    ds_read_b128 v[216:219], v22 offset:0
    ds_read_b128 v[220:223], v23 offset:0
    s_mul_i32 s63, s61, 3
    s_add_u32 m0, s62, 81920
    s_nop 0
    buffer_load_dwordx4 v11, s[16:19], s63 offen lds
    s_mul_i32 s63, s61, 3
    s_add_u32 s63, s63, s60
    s_add_u32 m0, s62, 82944
    s_nop 0
    buffer_load_dwordx4 v11, s[16:19], s63 offen lds
    v_mfma_f32_32x32x16_bf16 v[64:79], v[32:35], v[144:147], v[64:79]
    v_mfma_f32_32x32x16_bf16 v[80:95], v[36:39], v[144:147], v[80:95]
    v_mfma_f32_32x32x16_bf16 v[96:111], v[40:43], v[144:147], v[96:111]
    v_mfma_f32_32x32x16_bf16 v[112:127], v[44:47], v[144:147], v[112:127]
    s_waitcnt lgkmcnt(4)
    ds_read_b64_tr_b16 v[32:33], v2 offset:8192
    ds_read_b64_tr_b16 v[34:35], v2 offset:9216
    ds_read_b64_tr_b16 v[36:37], v3 offset:8192
    ds_read_b64_tr_b16 v[38:39], v3 offset:9216
    ds_read_b64_tr_b16 v[40:41], v2 offset:24576
    ds_read_b64_tr_b16 v[42:43], v2 offset:25600
    ds_read_b64_tr_b16 v[44:45], v3 offset:24576
    ds_read_b64_tr_b16 v[46:47], v3 offset:25600
    ds_read_b128 v[224:227], v16 offset:256
    ds_read_b128 v[228:231], v17 offset:256
    ds_read_b128 v[232:235], v18 offset:256
    ds_read_b128 v[236:239], v19 offset:256
    v_mfma_f32_32x32x16_bf16 v[64:79], v[48:51], v[148:151], v[64:79]
    v_mfma_f32_32x32x16_bf16 v[80:95], v[52:55], v[148:151], v[80:95]
    v_mfma_f32_32x32x16_bf16 v[96:111], v[56:59], v[148:151], v[96:111]
    v_mfma_f32_32x32x16_bf16 v[112:127], v[60:63], v[148:151], v[112:127]
    s_waitcnt lgkmcnt(4)
    ds_read_b64_tr_b16 v[48:49], v2 offset:12288
    ds_read_b64_tr_b16 v[50:51], v2 offset:13312
    ds_read_b64_tr_b16 v[52:53], v3 offset:12288
    ds_read_b64_tr_b16 v[54:55], v3 offset:13312
    ds_read_b64_tr_b16 v[56:57], v2 offset:28672
    ds_read_b64_tr_b16 v[58:59], v2 offset:29696
    ds_read_b64_tr_b16 v[60:61], v3 offset:28672
    ds_read_b64_tr_b16 v[62:63], v3 offset:29696
    ds_read_b128 v[240:243], v20 offset:256
    ds_read_b128 v[244:247], v21 offset:256
    ds_read_b128 v[248:251], v22 offset:256
    ds_read_b128 v[252:255], v23 offset:256
    v_mfma_f32_32x32x16_bf16 v[64:79], v[32:35], v[152:155], v[64:79]
    v_mfma_f32_32x32x16_bf16 v[80:95], v[36:39], v[152:155], v[80:95]
    v_mfma_f32_32x32x16_bf16 v[96:111], v[40:43], v[152:155], v[96:111]
    v_mfma_f32_32x32x16_bf16 v[112:127], v[44:47], v[152:155], v[112:127]
    s_waitcnt lgkmcnt(0)
    s_waitcnt vmcnt(4)
    s_barrier
    v_add_u32 v2, 131072, v27
    v_add_u32 v3, 131072, v28
    ds_read_b64_tr_b16 v[32:33], v2 offset:0
    ds_read_b64_tr_b16 v[34:35], v2 offset:1024
    ds_read_b64_tr_b16 v[36:37], v3 offset:0
    ds_read_b64_tr_b16 v[38:39], v3 offset:1024
    ds_read_b64_tr_b16 v[40:41], v2 offset:16384
    ds_read_b64_tr_b16 v[42:43], v2 offset:17408
    ds_read_b64_tr_b16 v[44:45], v3 offset:16384
    ds_read_b64_tr_b16 v[46:47], v3 offset:17408
    s_mul_i32 s63, s61, 4
    s_add_u32 m0, s62, 0
    s_nop 0
    buffer_load_dwordx4 v11, s[12:15], s63 offen lds
    s_mul_i32 s63, s61, 4
    s_add_u32 s63, s63, s60
    s_add_u32 m0, s62, 1024
    s_nop 0
    buffer_load_dwordx4 v11, s[12:15], s63 offen lds
    v_mfma_f32_32x32x16_bf16 v[64:79], v[48:51], v[156:159], v[64:79]
    v_mfma_f32_32x32x16_bf16 v[80:95], v[52:55], v[156:159], v[80:95]
    v_mfma_f32_32x32x16_bf16 v[96:111], v[56:59], v[156:159], v[96:111]
    v_mfma_f32_32x32x16_bf16 v[112:127], v[60:63], v[156:159], v[112:127]
    s_waitcnt lgkmcnt(0)
    ds_read_b64_tr_b16 v[48:49], v2 offset:4096
    ds_read_b64_tr_b16 v[50:51], v2 offset:5120
    ds_read_b64_tr_b16 v[52:53], v3 offset:4096
    ds_read_b64_tr_b16 v[54:55], v3 offset:5120
    ds_read_b64_tr_b16 v[56:57], v2 offset:20480
    ds_read_b64_tr_b16 v[58:59], v2 offset:21504
    ds_read_b64_tr_b16 v[60:61], v3 offset:20480
    ds_read_b64_tr_b16 v[62:63], v3 offset:21504
    s_mul_i32 s63, s61, 4
    s_add_u32 m0, s62, 16384
    s_nop 0
    buffer_load_dwordx4 v11, s[16:19], s63 offen lds
    s_mul_i32 s63, s61, 4
    s_add_u32 s63, s63, s60
    s_add_u32 m0, s62, 17408
    s_nop 0
    buffer_load_dwordx4 v11, s[16:19], s63 offen lds
    v_mfma_f32_32x32x16_bf16 v[64:79], v[32:35], v[160:163], v[64:79]
    v_mfma_f32_32x32x16_bf16 v[80:95], v[36:39], v[160:163], v[80:95]
    v_mfma_f32_32x32x16_bf16 v[96:111], v[40:43], v[160:163], v[96:111]
    v_mfma_f32_32x32x16_bf16 v[112:127], v[44:47], v[160:163], v[112:127]
    s_waitcnt lgkmcnt(0)
    ds_read_b64_tr_b16 v[32:33], v2 offset:8192
    ds_read_b64_tr_b16 v[34:35], v2 offset:9216
    ds_read_b64_tr_b16 v[36:37], v3 offset:8192
    ds_read_b64_tr_b16 v[38:39], v3 offset:9216
    ds_read_b64_tr_b16 v[40:41], v2 offset:24576
    ds_read_b64_tr_b16 v[42:43], v2 offset:25600
    ds_read_b64_tr_b16 v[44:45], v3 offset:24576
    ds_read_b64_tr_b16 v[46:47], v3 offset:25600
    s_mul_i32 s63, s61, 5
    s_add_u32 m0, s62, 32768
    s_nop 0
    buffer_load_dwordx4 v11, s[12:15], s63 offen lds
    s_mul_i32 s63, s61, 5
    s_add_u32 s63, s63, s60
    s_add_u32 m0, s62, 33792
    s_nop 0
    buffer_load_dwordx4 v11, s[12:15], s63 offen lds
    v_mfma_f32_32x32x16_bf16 v[64:79], v[48:51], v[164:167], v[64:79]
    v_mfma_f32_32x32x16_bf16 v[80:95], v[52:55], v[164:167], v[80:95]
    v_mfma_f32_32x32x16_bf16 v[96:111], v[56:59], v[164:167], v[96:111]
    v_mfma_f32_32x32x16_bf16 v[112:127], v[60:63], v[164:167], v[112:127]
    s_waitcnt lgkmcnt(0)
    ds_read_b64_tr_b16 v[48:49], v2 offset:12288
    ds_read_b64_tr_b16 v[50:51], v2 offset:13312
    ds_read_b64_tr_b16 v[52:53], v3 offset:12288
    ds_read_b64_tr_b16 v[54:55], v3 offset:13312
    ds_read_b64_tr_b16 v[56:57], v2 offset:28672
    ds_read_b64_tr_b16 v[58:59], v2 offset:29696
    ds_read_b64_tr_b16 v[60:61], v3 offset:28672
    ds_read_b64_tr_b16 v[62:63], v3 offset:29696
    s_mul_i32 s63, s61, 5
    s_add_u32 m0, s62, 49152
    s_nop 0
    buffer_load_dwordx4 v11, s[16:19], s63 offen lds
    s_mul_i32 s63, s61, 5
    s_add_u32 s63, s63, s60
    s_add_u32 m0, s62, 50176
    s_nop 0
    buffer_load_dwordx4 v11, s[16:19], s63 offen lds
    v_mfma_f32_32x32x16_bf16 v[64:79], v[32:35], v[168:171], v[64:79]
    v_mfma_f32_32x32x16_bf16 v[80:95], v[36:39], v[168:171], v[80:95]
    v_mfma_f32_32x32x16_bf16 v[96:111], v[40:43], v[168:171], v[96:111]
    v_mfma_f32_32x32x16_bf16 v[112:127], v[44:47], v[168:171], v[112:127]
    s_waitcnt lgkmcnt(0)
    s_waitcnt vmcnt(8)
    s_barrier
    v_add_u32 v2, 65536, v27
    v_add_u32 v3, 65536, v28
    ds_read_b64_tr_b16 v[32:33], v2 offset:0
    ds_read_b64_tr_b16 v[34:35], v2 offset:1024
    ds_read_b64_tr_b16 v[36:37], v3 offset:0
    ds_read_b64_tr_b16 v[38:39], v3 offset:1024
    ds_read_b64_tr_b16 v[40:41], v2 offset:16384
    ds_read_b64_tr_b16 v[42:43], v2 offset:17408
    ds_read_b64_tr_b16 v[44:45], v3 offset:16384
    ds_read_b64_tr_b16 v[46:47], v3 offset:17408
    s_mul_i32 s63, s61, 6
    s_add_u32 m0, s62, 98304
    s_nop 0
    buffer_load_dwordx4 v11, s[12:15], s63 offen lds
    s_mul_i32 s63, s61, 6
    s_add_u32 s63, s63, s60
    s_add_u32 m0, s62, 99328
    s_nop 0
    buffer_load_dwordx4 v11, s[12:15], s63 offen lds
    v_mfma_f32_32x32x16_bf16 v[64:79], v[48:51], v[172:175], v[64:79]
    v_mfma_f32_32x32x16_bf16 v[80:95], v[52:55], v[172:175], v[80:95]
    v_mfma_f32_32x32x16_bf16 v[96:111], v[56:59], v[172:175], v[96:111]
    v_mfma_f32_32x32x16_bf16 v[112:127], v[60:63], v[172:175], v[112:127]
    s_waitcnt lgkmcnt(0)
    ds_read_b64_tr_b16 v[48:49], v2 offset:4096
    ds_read_b64_tr_b16 v[50:51], v2 offset:5120
    ds_read_b64_tr_b16 v[52:53], v3 offset:4096
    ds_read_b64_tr_b16 v[54:55], v3 offset:5120
    ds_read_b64_tr_b16 v[56:57], v2 offset:20480
    ds_read_b64_tr_b16 v[58:59], v2 offset:21504
    ds_read_b64_tr_b16 v[60:61], v3 offset:20480
    ds_read_b64_tr_b16 v[62:63], v3 offset:21504
    s_mul_i32 s63, s61, 6
    s_add_u32 m0, s62, 114688
    s_nop 0
    buffer_load_dwordx4 v11, s[16:19], s63 offen lds
    s_mul_i32 s63, s61, 6
    s_add_u32 s63, s63, s60
    s_add_u32 m0, s62, 115712
    s_nop 0
    buffer_load_dwordx4 v11, s[16:19], s63 offen lds
    v_mfma_f32_32x32x16_bf16 v[64:79], v[32:35], v[176:179], v[64:79]
    v_mfma_f32_32x32x16_bf16 v[80:95], v[36:39], v[176:179], v[80:95]
    v_mfma_f32_32x32x16_bf16 v[96:111], v[40:43], v[176:179], v[96:111]
    v_mfma_f32_32x32x16_bf16 v[112:127], v[44:47], v[176:179], v[112:127]
    s_waitcnt lgkmcnt(0)
    ds_read_b64_tr_b16 v[32:33], v2 offset:8192
    ds_read_b64_tr_b16 v[34:35], v2 offset:9216
    ds_read_b64_tr_b16 v[36:37], v3 offset:8192
    ds_read_b64_tr_b16 v[38:39], v3 offset:9216
    ds_read_b64_tr_b16 v[40:41], v2 offset:24576
    ds_read_b64_tr_b16 v[42:43], v2 offset:25600
    ds_read_b64_tr_b16 v[44:45], v3 offset:24576
    ds_read_b64_tr_b16 v[46:47], v3 offset:25600
    s_mul_i32 s63, s61, 7
    s_add_u32 m0, s62, 131072
    s_nop 0
    buffer_load_dwordx4 v11, s[12:15], s63 offen lds
    s_mul_i32 s63, s61, 7
    s_add_u32 s63, s63, s60
    s_add_u32 m0, s62, 132096
    s_nop 0
    buffer_load_dwordx4 v11, s[12:15], s63 offen lds
    v_mfma_f32_32x32x16_bf16 v[64:79], v[48:51], v[180:183], v[64:79]
    v_mfma_f32_32x32x16_bf16 v[80:95], v[52:55], v[180:183], v[80:95]
    v_mfma_f32_32x32x16_bf16 v[96:111], v[56:59], v[180:183], v[96:111]
    v_mfma_f32_32x32x16_bf16 v[112:127], v[60:63], v[180:183], v[112:127]
    s_waitcnt lgkmcnt(0)
    ds_read_b64_tr_b16 v[48:49], v2 offset:12288
    ds_read_b64_tr_b16 v[50:51], v2 offset:13312
    ds_read_b64_tr_b16 v[52:53], v3 offset:12288
    ds_read_b64_tr_b16 v[54:55], v3 offset:13312
    ds_read_b64_tr_b16 v[56:57], v2 offset:28672
    ds_read_b64_tr_b16 v[58:59], v2 offset:29696
    ds_read_b64_tr_b16 v[60:61], v3 offset:28672
    ds_read_b64_tr_b16 v[62:63], v3 offset:29696
    s_mul_i32 s63, s61, 7
    s_add_u32 m0, s62, 147456
    s_nop 0
    buffer_load_dwordx4 v11, s[16:19], s63 offen lds
    s_mul_i32 s63, s61, 7
    s_add_u32 s63, s63, s60
    s_add_u32 m0, s62, 148480
    s_nop 0
    buffer_load_dwordx4 v11, s[16:19], s63 offen lds
    v_mfma_f32_32x32x16_bf16 v[64:79], v[32:35], v[184:187], v[64:79]
    v_mfma_f32_32x32x16_bf16 v[80:95], v[36:39], v[184:187], v[80:95]
    v_mfma_f32_32x32x16_bf16 v[96:111], v[40:43], v[184:187], v[96:111]
    v_mfma_f32_32x32x16_bf16 v[112:127], v[44:47], v[184:187], v[112:127]
    s_waitcnt lgkmcnt(0)
    s_waitcnt vmcnt(12)
    s_barrier
    v_add_u32 v2, 0, v27
    v_add_u32 v3, 0, v28
    ds_read_b64_tr_b16 v[32:33], v2 offset:0
    ds_read_b64_tr_b16 v[34:35], v2 offset:1024
    ds_read_b64_tr_b16 v[36:37], v3 offset:0
    ds_read_b64_tr_b16 v[38:39], v3 offset:1024
    ds_read_b64_tr_b16 v[40:41], v2 offset:16384
    ds_read_b64_tr_b16 v[42:43], v2 offset:17408
    ds_read_b64_tr_b16 v[44:45], v3 offset:16384
    ds_read_b64_tr_b16 v[46:47], v3 offset:17408
    v_mfma_f32_32x32x16_bf16 v[64:79], v[48:51], v[188:191], v[64:79]
    v_mfma_f32_32x32x16_bf16 v[80:95], v[52:55], v[188:191], v[80:95]
    v_mfma_f32_32x32x16_bf16 v[96:111], v[56:59], v[188:191], v[96:111]
    v_mfma_f32_32x32x16_bf16 v[112:127], v[60:63], v[188:191], v[112:127]
    s_waitcnt lgkmcnt(0)
    ds_read_b64_tr_b16 v[48:49], v2 offset:4096
    ds_read_b64_tr_b16 v[50:51], v2 offset:5120
    ds_read_b64_tr_b16 v[52:53], v3 offset:4096
    ds_read_b64_tr_b16 v[54:55], v3 offset:5120
    ds_read_b64_tr_b16 v[56:57], v2 offset:20480
    ds_read_b64_tr_b16 v[58:59], v2 offset:21504
    ds_read_b64_tr_b16 v[60:61], v3 offset:20480
    ds_read_b64_tr_b16 v[62:63], v3 offset:21504
    v_mfma_f32_32x32x16_bf16 v[64:79], v[32:35], v[192:195], v[64:79]
    v_mfma_f32_32x32x16_bf16 v[80:95], v[36:39], v[192:195], v[80:95]
    v_mfma_f32_32x32x16_bf16 v[96:111], v[40:43], v[192:195], v[96:111]
    v_mfma_f32_32x32x16_bf16 v[112:127], v[44:47], v[192:195], v[112:127]
    s_waitcnt lgkmcnt(0)
    ds_read_b64_tr_b16 v[32:33], v2 offset:8192
    ds_read_b64_tr_b16 v[34:35], v2 offset:9216
    ds_read_b64_tr_b16 v[36:37], v3 offset:8192
    ds_read_b64_tr_b16 v[38:39], v3 offset:9216
    ds_read_b64_tr_b16 v[40:41], v2 offset:24576
    ds_read_b64_tr_b16 v[42:43], v2 offset:25600
    ds_read_b64_tr_b16 v[44:45], v3 offset:24576
    ds_read_b64_tr_b16 v[46:47], v3 offset:25600
    v_mfma_f32_32x32x16_bf16 v[64:79], v[48:51], v[196:199], v[64:79]
    v_mfma_f32_32x32x16_bf16 v[80:95], v[52:55], v[196:199], v[80:95]
    v_mfma_f32_32x32x16_bf16 v[96:111], v[56:59], v[196:199], v[96:111]
    v_mfma_f32_32x32x16_bf16 v[112:127], v[60:63], v[196:199], v[112:127]
    s_waitcnt lgkmcnt(0)
    ds_read_b64_tr_b16 v[48:49], v2 offset:12288
    ds_read_b64_tr_b16 v[50:51], v2 offset:13312
    ds_read_b64_tr_b16 v[52:53], v3 offset:12288
    ds_read_b64_tr_b16 v[54:55], v3 offset:13312
    ds_read_b64_tr_b16 v[56:57], v2 offset:28672
    ds_read_b64_tr_b16 v[58:59], v2 offset:29696
    ds_read_b64_tr_b16 v[60:61], v3 offset:28672
    ds_read_b64_tr_b16 v[62:63], v3 offset:29696
    v_mfma_f32_32x32x16_bf16 v[64:79], v[32:35], v[200:203], v[64:79]
    v_mfma_f32_32x32x16_bf16 v[80:95], v[36:39], v[200:203], v[80:95]
    v_mfma_f32_32x32x16_bf16 v[96:111], v[40:43], v[200:203], v[96:111]
    v_mfma_f32_32x32x16_bf16 v[112:127], v[44:47], v[200:203], v[112:127]
    s_waitcnt lgkmcnt(0)
    s_waitcnt vmcnt(8)
    s_barrier
    v_add_u32 v2, 32768, v27
    v_add_u32 v3, 32768, v28
    ds_read_b64_tr_b16 v[32:33], v2 offset:0
    ds_read_b64_tr_b16 v[34:35], v2 offset:1024
    ds_read_b64_tr_b16 v[36:37], v3 offset:0
    ds_read_b64_tr_b16 v[38:39], v3 offset:1024
    ds_read_b64_tr_b16 v[40:41], v2 offset:16384
    ds_read_b64_tr_b16 v[42:43], v2 offset:17408
    ds_read_b64_tr_b16 v[44:45], v3 offset:16384
    ds_read_b64_tr_b16 v[46:47], v3 offset:17408
    v_mfma_f32_32x32x16_bf16 v[64:79], v[48:51], v[204:207], v[64:79]
    v_mfma_f32_32x32x16_bf16 v[80:95], v[52:55], v[204:207], v[80:95]
    v_mfma_f32_32x32x16_bf16 v[96:111], v[56:59], v[204:207], v[96:111]
    v_mfma_f32_32x32x16_bf16 v[112:127], v[60:63], v[204:207], v[112:127]
    s_waitcnt lgkmcnt(0)
    ds_read_b64_tr_b16 v[48:49], v2 offset:4096
    ds_read_b64_tr_b16 v[50:51], v2 offset:5120
    ds_read_b64_tr_b16 v[52:53], v3 offset:4096
    ds_read_b64_tr_b16 v[54:55], v3 offset:5120
    ds_read_b64_tr_b16 v[56:57], v2 offset:20480
    ds_read_b64_tr_b16 v[58:59], v2 offset:21504
    ds_read_b64_tr_b16 v[60:61], v3 offset:20480
    ds_read_b64_tr_b16 v[62:63], v3 offset:21504
    buffer_load_ushort v16, v24, s[24:27], s30 offen offset:0
    v_mfma_f32_32x32x16_bf16 v[64:79], v[32:35], v[208:211], v[64:79]
    v_mfma_f32_32x32x16_bf16 v[80:95], v[36:39], v[208:211], v[80:95]
    v_mfma_f32_32x32x16_bf16 v[96:111], v[40:43], v[208:211], v[96:111]
    v_mfma_f32_32x32x16_bf16 v[112:127], v[44:47], v[208:211], v[112:127]
    s_waitcnt lgkmcnt(0)
    ds_read_b64_tr_b16 v[32:33], v2 offset:8192
    ds_read_b64_tr_b16 v[34:35], v2 offset:9216
    ds_read_b64_tr_b16 v[36:37], v3 offset:8192
    ds_read_b64_tr_b16 v[38:39], v3 offset:9216
    ds_read_b64_tr_b16 v[40:41], v2 offset:24576
    ds_read_b64_tr_b16 v[42:43], v2 offset:25600
    ds_read_b64_tr_b16 v[44:45], v3 offset:24576
    ds_read_b64_tr_b16 v[46:47], v3 offset:25600
    buffer_load_ushort v17, v24, s[24:27], s30 offen offset:1024
    v_mfma_f32_32x32x16_bf16 v[64:79], v[48:51], v[212:215], v[64:79]
    v_mfma_f32_32x32x16_bf16 v[80:95], v[52:55], v[212:215], v[80:95]
    v_mfma_f32_32x32x16_bf16 v[96:111], v[56:59], v[212:215], v[96:111]
    v_mfma_f32_32x32x16_bf16 v[112:127], v[60:63], v[212:215], v[112:127]
    s_waitcnt lgkmcnt(0)
    ds_read_b64_tr_b16 v[48:49], v2 offset:12288
    ds_read_b64_tr_b16 v[50:51], v2 offset:13312
    ds_read_b64_tr_b16 v[52:53], v3 offset:12288
    ds_read_b64_tr_b16 v[54:55], v3 offset:13312
    ds_read_b64_tr_b16 v[56:57], v2 offset:28672
    ds_read_b64_tr_b16 v[58:59], v2 offset:29696
    ds_read_b64_tr_b16 v[60:61], v3 offset:28672
    ds_read_b64_tr_b16 v[62:63], v3 offset:29696
    buffer_load_ushort v18, v24, s[24:27], s30 offen offset:2048
    v_mfma_f32_32x32x16_bf16 v[64:79], v[32:35], v[216:219], v[64:79]
    v_mfma_f32_32x32x16_bf16 v[80:95], v[36:39], v[216:219], v[80:95]
    v_mfma_f32_32x32x16_bf16 v[96:111], v[40:43], v[216:219], v[96:111]
    v_mfma_f32_32x32x16_bf16 v[112:127], v[44:47], v[216:219], v[112:127]
    s_waitcnt lgkmcnt(0)
    s_waitcnt vmcnt(7)
    s_barrier
    v_add_u32 v2, 98304, v27
    v_add_u32 v3, 98304, v28
    ds_read_b64_tr_b16 v[32:33], v2 offset:0
    ds_read_b64_tr_b16 v[34:35], v2 offset:1024
    ds_read_b64_tr_b16 v[36:37], v3 offset:0
    ds_read_b64_tr_b16 v[38:39], v3 offset:1024
    ds_read_b64_tr_b16 v[40:41], v2 offset:16384
    ds_read_b64_tr_b16 v[42:43], v2 offset:17408
    ds_read_b64_tr_b16 v[44:45], v3 offset:16384
    ds_read_b64_tr_b16 v[46:47], v3 offset:17408
    buffer_load_ushort v19, v24, s[24:27], s30 offen offset:3072
    v_mfma_f32_32x32x16_bf16 v[64:79], v[48:51], v[220:223], v[64:79]
    v_mfma_f32_32x32x16_bf16 v[80:95], v[52:55], v[220:223], v[80:95]
    v_mfma_f32_32x32x16_bf16 v[96:111], v[56:59], v[220:223], v[96:111]
    v_mfma_f32_32x32x16_bf16 v[112:127], v[60:63], v[220:223], v[112:127]
    s_waitcnt lgkmcnt(0)
    ds_read_b64_tr_b16 v[48:49], v2 offset:4096
    ds_read_b64_tr_b16 v[50:51], v2 offset:5120
    ds_read_b64_tr_b16 v[52:53], v3 offset:4096
    ds_read_b64_tr_b16 v[54:55], v3 offset:5120
    ds_read_b64_tr_b16 v[56:57], v2 offset:20480
    ds_read_b64_tr_b16 v[58:59], v2 offset:21504
    ds_read_b64_tr_b16 v[60:61], v3 offset:20480
    ds_read_b64_tr_b16 v[62:63], v3 offset:21504
    buffer_load_ushort v20, v24, s[24:27], s31 offen offset:0
    v_mfma_f32_32x32x16_bf16 v[64:79], v[32:35], v[224:227], v[64:79]
    v_mfma_f32_32x32x16_bf16 v[80:95], v[36:39], v[224:227], v[80:95]
    v_mfma_f32_32x32x16_bf16 v[96:111], v[40:43], v[224:227], v[96:111]
    v_mfma_f32_32x32x16_bf16 v[112:127], v[44:47], v[224:227], v[112:127]
    s_waitcnt lgkmcnt(0)
    ds_read_b64_tr_b16 v[32:33], v2 offset:8192
    ds_read_b64_tr_b16 v[34:35], v2 offset:9216
    ds_read_b64_tr_b16 v[36:37], v3 offset:8192
    ds_read_b64_tr_b16 v[38:39], v3 offset:9216
    ds_read_b64_tr_b16 v[40:41], v2 offset:24576
    ds_read_b64_tr_b16 v[42:43], v2 offset:25600
    ds_read_b64_tr_b16 v[44:45], v3 offset:24576
    ds_read_b64_tr_b16 v[46:47], v3 offset:25600
    buffer_load_ushort v21, v24, s[24:27], s31 offen offset:1024
    v_mfma_f32_32x32x16_bf16 v[64:79], v[48:51], v[228:231], v[64:79]
    v_mfma_f32_32x32x16_bf16 v[80:95], v[52:55], v[228:231], v[80:95]
    v_mfma_f32_32x32x16_bf16 v[96:111], v[56:59], v[228:231], v[96:111]
    v_mfma_f32_32x32x16_bf16 v[112:127], v[60:63], v[228:231], v[112:127]
    s_waitcnt lgkmcnt(0)
    ds_read_b64_tr_b16 v[48:49], v2 offset:12288
    ds_read_b64_tr_b16 v[50:51], v2 offset:13312
    ds_read_b64_tr_b16 v[52:53], v3 offset:12288
    ds_read_b64_tr_b16 v[54:55], v3 offset:13312
    ds_read_b64_tr_b16 v[56:57], v2 offset:28672
    ds_read_b64_tr_b16 v[58:59], v2 offset:29696
    ds_read_b64_tr_b16 v[60:61], v3 offset:28672
    ds_read_b64_tr_b16 v[62:63], v3 offset:29696
    buffer_load_ushort v22, v24, s[24:27], s31 offen offset:2048
    v_mfma_f32_32x32x16_bf16 v[64:79], v[32:35], v[232:235], v[64:79]
    v_mfma_f32_32x32x16_bf16 v[80:95], v[36:39], v[232:235], v[80:95]
    v_mfma_f32_32x32x16_bf16 v[96:111], v[40:43], v[232:235], v[96:111]
    v_mfma_f32_32x32x16_bf16 v[112:127], v[44:47], v[232:235], v[112:127]
    s_waitcnt lgkmcnt(0)
    s_waitcnt vmcnt(7)
    s_barrier
    v_add_u32 v2, 131072, v27
    v_add_u32 v3, 131072, v28
    ds_read_b64_tr_b16 v[32:33], v2 offset:0
    ds_read_b64_tr_b16 v[34:35], v2 offset:1024
    ds_read_b64_tr_b16 v[36:37], v3 offset:0
    ds_read_b64_tr_b16 v[38:39], v3 offset:1024
    ds_read_b64_tr_b16 v[40:41], v2 offset:16384
    ds_read_b64_tr_b16 v[42:43], v2 offset:17408
    ds_read_b64_tr_b16 v[44:45], v3 offset:16384
    ds_read_b64_tr_b16 v[46:47], v3 offset:17408
    buffer_load_ushort v23, v24, s[24:27], s31 offen offset:3072
    v_mfma_f32_32x32x16_bf16 v[64:79], v[48:51], v[236:239], v[64:79]
    v_mfma_f32_32x32x16_bf16 v[80:95], v[52:55], v[236:239], v[80:95]
    v_mfma_f32_32x32x16_bf16 v[96:111], v[56:59], v[236:239], v[96:111]
    v_mfma_f32_32x32x16_bf16 v[112:127], v[60:63], v[236:239], v[112:127]
    s_waitcnt lgkmcnt(0)
    ds_read_b64_tr_b16 v[48:49], v2 offset:4096
    ds_read_b64_tr_b16 v[50:51], v2 offset:5120
    ds_read_b64_tr_b16 v[52:53], v3 offset:4096
    ds_read_b64_tr_b16 v[54:55], v3 offset:5120
    ds_read_b64_tr_b16 v[56:57], v2 offset:20480
    ds_read_b64_tr_b16 v[58:59], v2 offset:21504
    ds_read_b64_tr_b16 v[60:61], v3 offset:20480
    ds_read_b64_tr_b16 v[62:63], v3 offset:21504
    v_mfma_f32_32x32x16_bf16 v[64:79], v[32:35], v[240:243], v[64:79]
    v_mfma_f32_32x32x16_bf16 v[80:95], v[36:39], v[240:243], v[80:95]
    v_mfma_f32_32x32x16_bf16 v[96:111], v[40:43], v[240:243], v[96:111]
    v_mfma_f32_32x32x16_bf16 v[112:127], v[44:47], v[240:243], v[112:127]
    s_waitcnt lgkmcnt(0)
    ds_read_b64_tr_b16 v[32:33], v2 offset:8192
    ds_read_b64_tr_b16 v[34:35], v2 offset:9216
    ds_read_b64_tr_b16 v[36:37], v3 offset:8192
    ds_read_b64_tr_b16 v[38:39], v3 offset:9216
    ds_read_b64_tr_b16 v[40:41], v2 offset:24576
    ds_read_b64_tr_b16 v[42:43], v2 offset:25600
    ds_read_b64_tr_b16 v[44:45], v3 offset:24576
    ds_read_b64_tr_b16 v[46:47], v3 offset:25600
    v_mfma_f32_32x32x16_bf16 v[64:79], v[48:51], v[244:247], v[64:79]
    v_mfma_f32_32x32x16_bf16 v[80:95], v[52:55], v[244:247], v[80:95]
    v_mfma_f32_32x32x16_bf16 v[96:111], v[56:59], v[244:247], v[96:111]
    v_mfma_f32_32x32x16_bf16 v[112:127], v[60:63], v[244:247], v[112:127]
    s_waitcnt lgkmcnt(0)
    ds_read_b64_tr_b16 v[48:49], v2 offset:12288
    ds_read_b64_tr_b16 v[50:51], v2 offset:13312
    ds_read_b64_tr_b16 v[52:53], v3 offset:12288
    ds_read_b64_tr_b16 v[54:55], v3 offset:13312
    ds_read_b64_tr_b16 v[56:57], v2 offset:28672
    ds_read_b64_tr_b16 v[58:59], v2 offset:29696
    ds_read_b64_tr_b16 v[60:61], v3 offset:28672
    ds_read_b64_tr_b16 v[62:63], v3 offset:29696
    v_mfma_f32_32x32x16_bf16 v[64:79], v[32:35], v[248:251], v[64:79]
    v_mfma_f32_32x32x16_bf16 v[80:95], v[36:39], v[248:251], v[80:95]
    v_mfma_f32_32x32x16_bf16 v[96:111], v[40:43], v[248:251], v[96:111]
    v_mfma_f32_32x32x16_bf16 v[112:127], v[44:47], v[248:251], v[112:127]
    s_waitcnt lgkmcnt(0)
    v_mfma_f32_32x32x16_bf16 v[64:79], v[48:51], v[252:255], v[64:79]
    v_mfma_f32_32x32x16_bf16 v[80:95], v[52:55], v[252:255], v[80:95]
    v_mfma_f32_32x32x16_bf16 v[96:111], v[56:59], v[252:255], v[96:111]
    v_mfma_f32_32x32x16_bf16 v[112:127], v[60:63], v[252:255], v[112:127]
    s_lshl_b32 s20, s5, 2
    s_add_u32 s20, s20, s72
    s_mul_i32 s20, s20, 114688
    s_lshl_b32 s21, s6, 3
    s_lshl_b32 s22, s73, 2
    s_add_u32 s21, s21, s22
    s_lshl_b32 s21, s21, 10
    s_add_u32 s20, s20, s21
    s_waitcnt vmcnt(0)
    v_lshl_or_b32 v4, v17, 16, v16
    v_lshl_or_b32 v5, v19, 16, v18
    v_lshl_or_b32 v6, v21, 16, v20
    v_lshl_or_b32 v7, v23, 16, v22
    s_cmp_ge_u32 s2, 224
    s_cbranch_scc1 K1_NOWD_g
    buffer_store_dwordx4 v[4:7], v14, s[32:35], s66 offen sc0 sc1
K1_NOWD_g:
    v_mul_f32 v30, v15, v15
    s_nop 7
    v_max_f32 v64, 0, v64
    v_max_f32 v65, 0, v65
    v_pk_mul_f32 v[96:97], v[96:97], v[30:31] op_sel_hi:[1,0]
    v_pk_mul_f32 v[64:65], v[64:65], v[96:97]
    v_max_f32 v66, 0, v66
    v_max_f32 v67, 0, v67
    v_pk_mul_f32 v[98:99], v[98:99], v[30:31] op_sel_hi:[1,0]
    v_pk_mul_f32 v[66:67], v[66:67], v[98:99]
    v_max_f32 v68, 0, v68
    v_max_f32 v69, 0, v69
    v_pk_mul_f32 v[100:101], v[100:101], v[30:31] op_sel_hi:[1,0]
    v_pk_mul_f32 v[68:69], v[68:69], v[100:101]
    v_max_f32 v70, 0, v70
    v_max_f32 v71, 0, v71
    v_pk_mul_f32 v[102:103], v[102:103], v[30:31] op_sel_hi:[1,0]
    v_pk_mul_f32 v[70:71], v[70:71], v[102:103]
    v_max_f32 v72, 0, v72
    v_max_f32 v73, 0, v73
    v_pk_mul_f32 v[104:105], v[104:105], v[30:31] op_sel_hi:[1,0]
    v_pk_mul_f32 v[72:73], v[72:73], v[104:105]
    v_max_f32 v74, 0, v74
    v_max_f32 v75, 0, v75
    v_pk_mul_f32 v[106:107], v[106:107], v[30:31] op_sel_hi:[1,0]
    v_pk_mul_f32 v[74:75], v[74:75], v[106:107]
    v_max_f32 v76, 0, v76
    v_max_f32 v77, 0, v77
    v_pk_mul_f32 v[108:109], v[108:109], v[30:31] op_sel_hi:[1,0]
    v_pk_mul_f32 v[76:77], v[76:77], v[108:109]
    v_max_f32 v78, 0, v78
    v_max_f32 v79, 0, v79
    v_pk_mul_f32 v[110:111], v[110:111], v[30:31] op_sel_hi:[1,0]
    v_pk_mul_f32 v[78:79], v[78:79], v[110:111]
    v_cvt_pk_bf16_f32 v32, v64, v65
    v_cvt_pk_bf16_f32 v33, v66, v67
    v_cvt_pk_bf16_f32 v34, v68, v69
    v_cvt_pk_bf16_f32 v35, v70, v71
    v_cvt_pk_bf16_f32 v36, v72, v73
    v_cvt_pk_bf16_f32 v37, v74, v75
    v_cvt_pk_bf16_f32 v38, v76, v77
    v_cvt_pk_bf16_f32 v39, v78, v79
    buffer_store_dwordx4 v[32:35], v14, s[32:35], s20 offen offset:0 sc0 sc1
    buffer_store_dwordx4 v[36:39], v14, s[32:35], s20 offen offset:1024 sc0 sc1
    v_max_f32 v80, 0, v80
    v_max_f32 v81, 0, v81
    v_pk_mul_f32 v[112:113], v[112:113], v[30:31] op_sel_hi:[1,0]
    v_pk_mul_f32 v[80:81], v[80:81], v[112:113]
    v_max_f32 v82, 0, v82
    v_max_f32 v83, 0, v83
    v_pk_mul_f32 v[114:115], v[114:115], v[30:31] op_sel_hi:[1,0]
    v_pk_mul_f32 v[82:83], v[82:83], v[114:115]
    v_max_f32 v84, 0, v84
    v_max_f32 v85, 0, v85
    v_pk_mul_f32 v[116:117], v[116:117], v[30:31] op_sel_hi:[1,0]
    v_pk_mul_f32 v[84:85], v[84:85], v[116:117]
    v_max_f32 v86, 0, v86
    v_max_f32 v87, 0, v87
    v_pk_mul_f32 v[118:119], v[118:119], v[30:31] op_sel_hi:[1,0]
    v_pk_mul_f32 v[86:87], v[86:87], v[118:119]
    v_max_f32 v88, 0, v88
    v_max_f32 v89, 0, v89
    v_pk_mul_f32 v[120:121], v[120:121], v[30:31] op_sel_hi:[1,0]
    v_pk_mul_f32 v[88:89], v[88:89], v[120:121]
    v_max_f32 v90, 0, v90
    v_max_f32 v91, 0, v91
    v_pk_mul_f32 v[122:123], v[122:123], v[30:31] op_sel_hi:[1,0]
    v_pk_mul_f32 v[90:91], v[90:91], v[122:123]
    v_max_f32 v92, 0, v92
    v_max_f32 v93, 0, v93
    v_pk_mul_f32 v[124:125], v[124:125], v[30:31] op_sel_hi:[1,0]
    v_pk_mul_f32 v[92:93], v[92:93], v[124:125]
    v_max_f32 v94, 0, v94
    v_max_f32 v95, 0, v95
    v_pk_mul_f32 v[126:127], v[126:127], v[30:31] op_sel_hi:[1,0]
    v_pk_mul_f32 v[94:95], v[94:95], v[126:127]
    v_cvt_pk_bf16_f32 v40, v80, v81
    v_cvt_pk_bf16_f32 v41, v82, v83
    v_cvt_pk_bf16_f32 v42, v84, v85
    v_cvt_pk_bf16_f32 v43, v86, v87
    v_cvt_pk_bf16_f32 v44, v88, v89
    v_cvt_pk_bf16_f32 v45, v90, v91
    v_cvt_pk_bf16_f32 v46, v92, v93
    v_cvt_pk_bf16_f32 v47, v94, v95
    buffer_store_dwordx4 v[40:43], v14, s[32:35], s20 offen offset:2048 sc0 sc1
    buffer_store_dwordx4 v[44:47], v14, s[32:35], s20 offen offset:3072 sc0 sc1
    s_waitcnt vmcnt(0)
    s_endpgm
K1_MAIN_DFT:
    v_add_u32 v2, 65536, v27
    v_add_u32 v3, 65536, v28
    ds_read_b64_tr_b16 v[32:33], v2 offset:0
    ds_read_b64_tr_b16 v[34:35], v2 offset:1024
    ds_read_b64_tr_b16 v[36:37], v3 offset:0
    ds_read_b64_tr_b16 v[38:39], v3 offset:1024
    ds_read_b64_tr_b16 v[40:41], v2 offset:16384
    ds_read_b64_tr_b16 v[42:43], v2 offset:17408
    ds_read_b64_tr_b16 v[44:45], v3 offset:16384
    ds_read_b64_tr_b16 v[46:47], v3 offset:17408
    ds_write2_b64 v7, v[80:81], v[82:83] offset0:0 offset1:1
    ds_write2_b64 v8, v[112:113], v[114:115] offset0:0 offset1:1
    ds_write2_b64 v5, v[84:85], v[86:87] offset0:0 offset1:1
    ds_write2_b64 v6, v[116:117], v[118:119] offset0:0 offset1:1
    ds_write2_b64 v7, v[88:89], v[90:91] offset0:32 offset1:33
    ds_write2_b64 v8, v[120:121], v[122:123] offset0:32 offset1:33
    ds_write2_b64 v5, v[92:93], v[94:95] offset0:32 offset1:33
    ds_write2_b64 v6, v[124:125], v[126:127] offset0:32 offset1:33
    s_waitcnt lgkmcnt(8)
    ds_read_b64_tr_b16 v[48:49], v2 offset:4096
    ds_read_b64_tr_b16 v[50:51], v2 offset:5120
    ds_read_b64_tr_b16 v[52:53], v3 offset:4096
    ds_read_b64_tr_b16 v[54:55], v3 offset:5120
    ds_read_b64_tr_b16 v[56:57], v2 offset:20480
    ds_read_b64_tr_b16 v[58:59], v2 offset:21504
    ds_read_b64_tr_b16 v[60:61], v3 offset:20480
    ds_read_b64_tr_b16 v[62:63], v3 offset:21504
    v_xor_b32 v32, v29, v32
    v_xor_b32 v33, v29, v33
    v_xor_b32 v34, v29, v34
    v_xor_b32 v35, v29, v35
    v_mfma_f32_32x32x16_bf16 v[80:95], v[128:131], v[36:39], 0
    v_mfma_f32_32x32x16_bf16 v[96:111], v[128:131], v[40:43], 0
    v_mfma_f32_32x32x16_bf16 v[112:127], v[128:131], v[44:47], 0
    v_mfma_f32_32x32x16_bf16 v[64:79], v[128:131], v[32:35], 0
    s_waitcnt lgkmcnt(0)
    ds_read_b64_tr_b16 v[32:33], v2 offset:8192
    ds_read_b64_tr_b16 v[34:35], v2 offset:9216
    ds_read_b64_tr_b16 v[36:37], v3 offset:8192
    ds_read_b64_tr_b16 v[38:39], v3 offset:9216
    ds_read_b64_tr_b16 v[40:41], v2 offset:24576
    ds_read_b64_tr_b16 v[42:43], v2 offset:25600
    ds_read_b64_tr_b16 v[44:45], v3 offset:24576
    ds_read_b64_tr_b16 v[46:47], v3 offset:25600
    v_xor_b32 v48, v29, v48
    v_xor_b32 v49, v29, v49
    v_xor_b32 v50, v29, v50
    v_xor_b32 v51, v29, v51
    v_mfma_f32_32x32x16_bf16 v[80:95], v[132:135], v[52:55], v[80:95]
    v_mfma_f32_32x32x16_bf16 v[96:111], v[132:135], v[56:59], v[96:111]
    v_mfma_f32_32x32x16_bf16 v[112:127], v[132:135], v[60:63], v[112:127]
    v_mfma_f32_32x32x16_bf16 v[64:79], v[132:135], v[48:51], v[64:79]
    s_waitcnt lgkmcnt(0)
    ds_read_b64_tr_b16 v[48:49], v2 offset:12288
    ds_read_b64_tr_b16 v[50:51], v2 offset:13312
    ds_read_b64_tr_b16 v[52:53], v3 offset:12288
    ds_read_b64_tr_b16 v[54:55], v3 offset:13312
    ds_read_b64_tr_b16 v[56:57], v2 offset:28672
    ds_read_b64_tr_b16 v[58:59], v2 offset:29696
    ds_read_b64_tr_b16 v[60:61], v3 offset:28672
    ds_read_b64_tr_b16 v[62:63], v3 offset:29696
    v_xor_b32 v32, v29, v32
    v_xor_b32 v33, v29, v33
    v_xor_b32 v34, v29, v34
    v_xor_b32 v35, v29, v35
    v_mfma_f32_32x32x16_bf16 v[80:95], v[136:139], v[36:39], v[80:95]
    v_mfma_f32_32x32x16_bf16 v[96:111], v[136:139], v[40:43], v[96:111]
    v_mfma_f32_32x32x16_bf16 v[112:127], v[136:139], v[44:47], v[112:127]
    v_mfma_f32_32x32x16_bf16 v[64:79], v[136:139], v[32:35], v[64:79]
    s_waitcnt lgkmcnt(0)
    s_waitcnt vmcnt(4)
    s_barrier
    v_add_u32 v2, 98304, v27
    v_add_u32 v3, 98304, v28
    ds_read_b64_tr_b16 v[32:33], v2 offset:0
    ds_read_b64_tr_b16 v[34:35], v2 offset:1024
    ds_read_b64_tr_b16 v[36:37], v3 offset:0
    ds_read_b64_tr_b16 v[38:39], v3 offset:1024
    ds_read_b64_tr_b16 v[40:41], v2 offset:16384
    ds_read_b64_tr_b16 v[42:43], v2 offset:17408
    ds_read_b64_tr_b16 v[44:45], v3 offset:16384
    ds_read_b64_tr_b16 v[46:47], v3 offset:17408
    ds_read_b128 v[192:195], v16 offset:0
    ds_read_b128 v[196:199], v17 offset:0
    ds_read_b128 v[200:203], v18 offset:0
    ds_read_b128 v[204:207], v19 offset:0
    s_mul_i32 s63, s61, 3
    s_add_u32 m0, s62, 65536
    s_nop 0
    buffer_load_dwordx4 v11, s[12:15], s63 offen lds
    s_mul_i32 s63, s61, 3
    s_add_u32 s63, s63, s60
    s_add_u32 m0, s62, 66560
    s_nop 0
    buffer_load_dwordx4 v11, s[12:15], s63 offen lds
    v_xor_b32 v48, v29, v48
    v_xor_b32 v49, v29, v49
    v_xor_b32 v50, v29, v50
    v_xor_b32 v51, v29, v51
    v_mfma_f32_32x32x16_bf16 v[80:95], v[140:143], v[52:55], v[80:95]
    v_mfma_f32_32x32x16_bf16 v[96:111], v[140:143], v[56:59], v[96:111]
    v_mfma_f32_32x32x16_bf16 v[112:127], v[140:143], v[60:63], v[112:127]
    v_mfma_f32_32x32x16_bf16 v[64:79], v[140:143], v[48:51], v[64:79]
    s_waitcnt lgkmcnt(4)
    ds_read_b64_tr_b16 v[48:49], v2 offset:4096
    ds_read_b64_tr_b16 v[50:51], v2 offset:5120
    ds_read_b64_tr_b16 v[52:53], v3 offset:4096
    ds_read_b64_tr_b16 v[54:55], v3 offset:5120
    ds_read_b64_tr_b16 v[56:57], v2 offset:20480
    ds_read_b64_tr_b16 v[58:59], v2 offset:21504
    ds_read_b64_tr_b16 v[60:61], v3 offset:20480
    ds_read_b64_tr_b16 v[62:63], v3 offset:21504
    ds_read_b128 v[208:211], v20 offset:0
    ds_read_b128 v[212:215], v21 offset:0
    ds_read_b128 v[216:219], v22 offset:0
    ds_read_b128 v[220:223], v23 offset:0
    s_mul_i32 s63, s61, 3
    s_add_u32 m0, s62, 81920
    s_nop 0
    buffer_load_dwordx4 v11, s[16:19], s63 offen lds
    s_mul_i32 s63, s61, 3
    s_add_u32 s63, s63, s60
    s_add_u32 m0, s62, 82944
    s_nop 0
    buffer_load_dwordx4 v11, s[16:19], s63 offen lds
    v_xor_b32 v32, v29, v32
    v_xor_b32 v33, v29, v33
    v_xor_b32 v34, v29, v34
    v_xor_b32 v35, v29, v35
    v_mfma_f32_32x32x16_bf16 v[80:95], v[144:147], v[36:39], v[80:95]
    v_mfma_f32_32x32x16_bf16 v[96:111], v[144:147], v[40:43], v[96:111]
    v_mfma_f32_32x32x16_bf16 v[112:127], v[144:147], v[44:47], v[112:127]
    v_mfma_f32_32x32x16_bf16 v[64:79], v[144:147], v[32:35], v[64:79]
    s_waitcnt lgkmcnt(4)
    ds_read_b64_tr_b16 v[32:33], v2 offset:8192
    ds_read_b64_tr_b16 v[34:35], v2 offset:9216
    ds_read_b64_tr_b16 v[36:37], v3 offset:8192
    ds_read_b64_tr_b16 v[38:39], v3 offset:9216
    ds_read_b64_tr_b16 v[40:41], v2 offset:24576
    ds_read_b64_tr_b16 v[42:43], v2 offset:25600
    ds_read_b64_tr_b16 v[44:45], v3 offset:24576
    ds_read_b64_tr_b16 v[46:47], v3 offset:25600
    ds_read_b128 v[224:227], v16 offset:256
    ds_read_b128 v[228:231], v17 offset:256
    ds_read_b128 v[232:235], v18 offset:256
    ds_read_b128 v[236:239], v19 offset:256
    v_xor_b32 v48, v29, v48
    v_xor_b32 v49, v29, v49
    v_xor_b32 v50, v29, v50
    v_xor_b32 v51, v29, v51
    v_mfma_f32_32x32x16_bf16 v[80:95], v[148:151], v[52:55], v[80:95]
    v_mfma_f32_32x32x16_bf16 v[96:111], v[148:151], v[56:59], v[96:111]
    v_mfma_f32_32x32x16_bf16 v[112:127], v[148:151], v[60:63], v[112:127]
    v_mfma_f32_32x32x16_bf16 v[64:79], v[148:151], v[48:51], v[64:79]
    s_waitcnt lgkmcnt(4)
    ds_read_b64_tr_b16 v[48:49], v2 offset:12288
    ds_read_b64_tr_b16 v[50:51], v2 offset:13312
    ds_read_b64_tr_b16 v[52:53], v3 offset:12288
    ds_read_b64_tr_b16 v[54:55], v3 offset:13312
    ds_read_b64_tr_b16 v[56:57], v2 offset:28672
    ds_read_b64_tr_b16 v[58:59], v2 offset:29696
    ds_read_b64_tr_b16 v[60:61], v3 offset:28672
    ds_read_b64_tr_b16 v[62:63], v3 offset:29696
    ds_read_b128 v[240:243], v20 offset:256
    ds_read_b128 v[244:247], v21 offset:256
    ds_read_b128 v[248:251], v22 offset:256
    ds_read_b128 v[252:255], v23 offset:256
    v_xor_b32 v32, v29, v32
    v_xor_b32 v33, v29, v33
    v_xor_b32 v34, v29, v34
    v_xor_b32 v35, v29, v35
    v_mfma_f32_32x32x16_bf16 v[80:95], v[152:155], v[36:39], v[80:95]
    v_mfma_f32_32x32x16_bf16 v[96:111], v[152:155], v[40:43], v[96:111]
    v_mfma_f32_32x32x16_bf16 v[112:127], v[152:155], v[44:47], v[112:127]
    v_mfma_f32_32x32x16_bf16 v[64:79], v[152:155], v[32:35], v[64:79]
    s_waitcnt lgkmcnt(0)
    s_waitcnt vmcnt(4)
    s_barrier
    v_add_u32 v2, 131072, v27
    v_add_u32 v3, 131072, v28
    ds_read_b64_tr_b16 v[32:33], v2 offset:0
    ds_read_b64_tr_b16 v[34:35], v2 offset:1024
    ds_read_b64_tr_b16 v[36:37], v3 offset:0
    ds_read_b64_tr_b16 v[38:39], v3 offset:1024
    ds_read_b64_tr_b16 v[40:41], v2 offset:16384
    ds_read_b64_tr_b16 v[42:43], v2 offset:17408
    ds_read_b64_tr_b16 v[44:45], v3 offset:16384
    ds_read_b64_tr_b16 v[46:47], v3 offset:17408
    s_mul_i32 s63, s61, 4
    s_add_u32 m0, s62, 0
    s_nop 0
    buffer_load_dwordx4 v11, s[12:15], s63 offen lds
    s_mul_i32 s63, s61, 4
    s_add_u32 s63, s63, s60
    s_add_u32 m0, s62, 1024
    s_nop 0
    buffer_load_dwordx4 v11, s[12:15], s63 offen lds
    v_xor_b32 v48, v29, v48
    v_xor_b32 v49, v29, v49
    v_xor_b32 v50, v29, v50
    v_xor_b32 v51, v29, v51
    v_mfma_f32_32x32x16_bf16 v[80:95], v[156:159], v[52:55], v[80:95]
    v_mfma_f32_32x32x16_bf16 v[96:111], v[156:159], v[56:59], v[96:111]
    v_mfma_f32_32x32x16_bf16 v[112:127], v[156:159], v[60:63], v[112:127]
    v_mfma_f32_32x32x16_bf16 v[64:79], v[156:159], v[48:51], v[64:79]
    s_waitcnt lgkmcnt(0)
    ds_read_b64_tr_b16 v[48:49], v2 offset:4096
    ds_read_b64_tr_b16 v[50:51], v2 offset:5120
    ds_read_b64_tr_b16 v[52:53], v3 offset:4096
    ds_read_b64_tr_b16 v[54:55], v3 offset:5120
    ds_read_b64_tr_b16 v[56:57], v2 offset:20480
    ds_read_b64_tr_b16 v[58:59], v2 offset:21504
    ds_read_b64_tr_b16 v[60:61], v3 offset:20480
    ds_read_b64_tr_b16 v[62:63], v3 offset:21504
    s_mul_i32 s63, s61, 4
    s_add_u32 m0, s62, 16384
    s_nop 0
    buffer_load_dwordx4 v11, s[16:19], s63 offen lds
    s_mul_i32 s63, s61, 4
    s_add_u32 s63, s63, s60
    s_add_u32 m0, s62, 17408
    s_nop 0
    buffer_load_dwordx4 v11, s[16:19], s63 offen lds
    v_xor_b32 v32, v29, v32
    v_xor_b32 v33, v29, v33
    v_xor_b32 v34, v29, v34
    v_xor_b32 v35, v29, v35
    v_mfma_f32_32x32x16_bf16 v[80:95], v[160:163], v[36:39], v[80:95]
    v_mfma_f32_32x32x16_bf16 v[96:111], v[160:163], v[40:43], v[96:111]
    v_mfma_f32_32x32x16_bf16 v[112:127], v[160:163], v[44:47], v[112:127]
    v_mfma_f32_32x32x16_bf16 v[64:79], v[160:163], v[32:35], v[64:79]
    s_waitcnt lgkmcnt(0)
    ds_read_b64_tr_b16 v[32:33], v2 offset:8192
    ds_read_b64_tr_b16 v[34:35], v2 offset:9216
    ds_read_b64_tr_b16 v[36:37], v3 offset:8192
    ds_read_b64_tr_b16 v[38:39], v3 offset:9216
    ds_read_b64_tr_b16 v[40:41], v2 offset:24576
    ds_read_b64_tr_b16 v[42:43], v2 offset:25600
    ds_read_b64_tr_b16 v[44:45], v3 offset:24576
    ds_read_b64_tr_b16 v[46:47], v3 offset:25600
    s_mul_i32 s63, s61, 5
    s_add_u32 m0, s62, 32768
    s_nop 0
    buffer_load_dwordx4 v11, s[12:15], s63 offen lds
    s_mul_i32 s63, s61, 5
    s_add_u32 s63, s63, s60
    s_add_u32 m0, s62, 33792
    s_nop 0
    buffer_load_dwordx4 v11, s[12:15], s63 offen lds
    v_xor_b32 v48, v29, v48
    v_xor_b32 v49, v29, v49
    v_xor_b32 v50, v29, v50
    v_xor_b32 v51, v29, v51
    v_mfma_f32_32x32x16_bf16 v[80:95], v[164:167], v[52:55], v[80:95]
    v_mfma_f32_32x32x16_bf16 v[96:111], v[164:167], v[56:59], v[96:111]
    v_mfma_f32_32x32x16_bf16 v[112:127], v[164:167], v[60:63], v[112:127]
    v_mfma_f32_32x32x16_bf16 v[64:79], v[164:167], v[48:51], v[64:79]
    s_waitcnt lgkmcnt(0)
    ds_read_b64_tr_b16 v[48:49], v2 offset:12288
    ds_read_b64_tr_b16 v[50:51], v2 offset:13312
    ds_read_b64_tr_b16 v[52:53], v3 offset:12288
    ds_read_b64_tr_b16 v[54:55], v3 offset:13312
    ds_read_b64_tr_b16 v[56:57], v2 offset:28672
    ds_read_b64_tr_b16 v[58:59], v2 offset:29696
    ds_read_b64_tr_b16 v[60:61], v3 offset:28672
    ds_read_b64_tr_b16 v[62:63], v3 offset:29696
    s_mul_i32 s63, s61, 5
    s_add_u32 m0, s62, 49152
    s_nop 0
    buffer_load_dwordx4 v11, s[16:19], s63 offen lds
    s_mul_i32 s63, s61, 5
    s_add_u32 s63, s63, s60
    s_add_u32 m0, s62, 50176
    s_nop 0
    buffer_load_dwordx4 v11, s[16:19], s63 offen lds
    v_xor_b32 v32, v29, v32
    v_xor_b32 v33, v29, v33
    v_xor_b32 v34, v29, v34
    v_xor_b32 v35, v29, v35
    v_mfma_f32_32x32x16_bf16 v[80:95], v[168:171], v[36:39], v[80:95]
    v_mfma_f32_32x32x16_bf16 v[96:111], v[168:171], v[40:43], v[96:111]
    v_mfma_f32_32x32x16_bf16 v[112:127], v[168:171], v[44:47], v[112:127]
    v_mfma_f32_32x32x16_bf16 v[64:79], v[168:171], v[32:35], v[64:79]
    s_waitcnt lgkmcnt(0)
    s_waitcnt vmcnt(8)
    s_barrier
    v_add_u32 v2, 65536, v27
    v_add_u32 v3, 65536, v28
    ds_read_b64_tr_b16 v[32:33], v2 offset:0
    ds_read_b64_tr_b16 v[34:35], v2 offset:1024
    ds_read_b64_tr_b16 v[36:37], v3 offset:0
    ds_read_b64_tr_b16 v[38:39], v3 offset:1024
    ds_read_b64_tr_b16 v[40:41], v2 offset:16384
    ds_read_b64_tr_b16 v[42:43], v2 offset:17408
    ds_read_b64_tr_b16 v[44:45], v3 offset:16384
    ds_read_b64_tr_b16 v[46:47], v3 offset:17408
    s_mul_i32 s63, s61, 6
    s_add_u32 m0, s62, 98304
    s_nop 0
    buffer_load_dwordx4 v11, s[12:15], s63 offen lds
    s_mul_i32 s63, s61, 6
    s_add_u32 s63, s63, s60
    s_add_u32 m0, s62, 99328
    s_nop 0
    buffer_load_dwordx4 v11, s[12:15], s63 offen lds
    v_xor_b32 v48, v29, v48
    v_xor_b32 v49, v29, v49
    v_xor_b32 v50, v29, v50
    v_xor_b32 v51, v29, v51
    v_mfma_f32_32x32x16_bf16 v[80:95], v[172:175], v[52:55], v[80:95]
    v_mfma_f32_32x32x16_bf16 v[96:111], v[172:175], v[56:59], v[96:111]
    v_mfma_f32_32x32x16_bf16 v[112:127], v[172:175], v[60:63], v[112:127]
    v_mfma_f32_32x32x16_bf16 v[64:79], v[172:175], v[48:51], v[64:79]
    s_waitcnt lgkmcnt(0)
    ds_read_b64_tr_b16 v[48:49], v2 offset:4096
    ds_read_b64_tr_b16 v[50:51], v2 offset:5120
    ds_read_b64_tr_b16 v[52:53], v3 offset:4096
    ds_read_b64_tr_b16 v[54:55], v3 offset:5120
    ds_read_b64_tr_b16 v[56:57], v2 offset:20480
    ds_read_b64_tr_b16 v[58:59], v2 offset:21504
    ds_read_b64_tr_b16 v[60:61], v3 offset:20480
    ds_read_b64_tr_b16 v[62:63], v3 offset:21504
    s_mul_i32 s63, s61, 6
    s_add_u32 m0, s62, 114688
    s_nop 0
    buffer_load_dwordx4 v11, s[16:19], s63 offen lds
    s_mul_i32 s63, s61, 6
    s_add_u32 s63, s63, s60
    s_add_u32 m0, s62, 115712
    s_nop 0
    buffer_load_dwordx4 v11, s[16:19], s63 offen lds
    v_xor_b32 v32, v29, v32
    v_xor_b32 v33, v29, v33
    v_xor_b32 v34, v29, v34
    v_xor_b32 v35, v29, v35
    v_mfma_f32_32x32x16_bf16 v[80:95], v[176:179], v[36:39], v[80:95]
    v_mfma_f32_32x32x16_bf16 v[96:111], v[176:179], v[40:43], v[96:111]
    v_mfma_f32_32x32x16_bf16 v[112:127], v[176:179], v[44:47], v[112:127]
    v_mfma_f32_32x32x16_bf16 v[64:79], v[176:179], v[32:35], v[64:79]
    s_waitcnt lgkmcnt(0)
    ds_read_b64_tr_b16 v[32:33], v2 offset:8192
    ds_read_b64_tr_b16 v[34:35], v2 offset:9216
    ds_read_b64_tr_b16 v[36:37], v3 offset:8192
    ds_read_b64_tr_b16 v[38:39], v3 offset:9216
    ds_read_b64_tr_b16 v[40:41], v2 offset:24576
    ds_read_b64_tr_b16 v[42:43], v2 offset:25600
    ds_read_b64_tr_b16 v[44:45], v3 offset:24576
    ds_read_b64_tr_b16 v[46:47], v3 offset:25600
    s_mul_i32 s63, s61, 7
    s_add_u32 m0, s62, 131072
    s_nop 0
    buffer_load_dwordx4 v11, s[12:15], s63 offen lds
    s_mul_i32 s63, s61, 7
    s_add_u32 s63, s63, s60
    s_add_u32 m0, s62, 132096
    s_nop 0
    buffer_load_dwordx4 v11, s[12:15], s63 offen lds
    v_xor_b32 v48, v29, v48
    v_xor_b32 v49, v29, v49
    v_xor_b32 v50, v29, v50
    v_xor_b32 v51, v29, v51
    v_mfma_f32_32x32x16_bf16 v[80:95], v[180:183], v[52:55], v[80:95]
    v_mfma_f32_32x32x16_bf16 v[96:111], v[180:183], v[56:59], v[96:111]
    v_mfma_f32_32x32x16_bf16 v[112:127], v[180:183], v[60:63], v[112:127]
    v_mfma_f32_32x32x16_bf16 v[64:79], v[180:183], v[48:51], v[64:79]
    s_waitcnt lgkmcnt(0)
    ds_read_b64_tr_b16 v[48:49], v2 offset:12288
    ds_read_b64_tr_b16 v[50:51], v2 offset:13312
    ds_read_b64_tr_b16 v[52:53], v3 offset:12288
    ds_read_b64_tr_b16 v[54:55], v3 offset:13312
    ds_read_b64_tr_b16 v[56:57], v2 offset:28672
    ds_read_b64_tr_b16 v[58:59], v2 offset:29696
    ds_read_b64_tr_b16 v[60:61], v3 offset:28672
    ds_read_b64_tr_b16 v[62:63], v3 offset:29696
    s_mul_i32 s63, s61, 7
    s_add_u32 m0, s62, 147456
    s_nop 0
    buffer_load_dwordx4 v11, s[16:19], s63 offen lds
    s_mul_i32 s63, s61, 7
    s_add_u32 s63, s63, s60
    s_add_u32 m0, s62, 148480
    s_nop 0
    buffer_load_dwordx4 v11, s[16:19], s63 offen lds
    v_xor_b32 v32, v29, v32
    v_xor_b32 v33, v29, v33
    v_xor_b32 v34, v29, v34
    v_xor_b32 v35, v29, v35
    v_mfma_f32_32x32x16_bf16 v[80:95], v[184:187], v[36:39], v[80:95]
    v_mfma_f32_32x32x16_bf16 v[96:111], v[184:187], v[40:43], v[96:111]
    v_mfma_f32_32x32x16_bf16 v[112:127], v[184:187], v[44:47], v[112:127]
    v_mfma_f32_32x32x16_bf16 v[64:79], v[184:187], v[32:35], v[64:79]
    s_waitcnt lgkmcnt(0)
    s_waitcnt vmcnt(12)
    s_barrier
    v_add_u32 v2, 0, v27
    v_add_u32 v3, 0, v28
    ds_read_b64_tr_b16 v[32:33], v2 offset:0
    ds_read_b64_tr_b16 v[34:35], v2 offset:1024
    ds_read_b64_tr_b16 v[36:37], v3 offset:0
    ds_read_b64_tr_b16 v[38:39], v3 offset:1024
    ds_read_b64_tr_b16 v[40:41], v2 offset:16384
    ds_read_b64_tr_b16 v[42:43], v2 offset:17408
    ds_read_b64_tr_b16 v[44:45], v3 offset:16384
    ds_read_b64_tr_b16 v[46:47], v3 offset:17408
    v_xor_b32 v48, v29, v48
    v_xor_b32 v49, v29, v49
    v_xor_b32 v50, v29, v50
    v_xor_b32 v51, v29, v51
    v_mfma_f32_32x32x16_bf16 v[80:95], v[188:191], v[52:55], v[80:95]
    v_mfma_f32_32x32x16_bf16 v[96:111], v[188:191], v[56:59], v[96:111]
    v_mfma_f32_32x32x16_bf16 v[112:127], v[188:191], v[60:63], v[112:127]
    v_mfma_f32_32x32x16_bf16 v[64:79], v[188:191], v[48:51], v[64:79]
    s_waitcnt lgkmcnt(0)
    ds_read_b64_tr_b16 v[48:49], v2 offset:4096
    ds_read_b64_tr_b16 v[50:51], v2 offset:5120
    ds_read_b64_tr_b16 v[52:53], v3 offset:4096
    ds_read_b64_tr_b16 v[54:55], v3 offset:5120
    ds_read_b64_tr_b16 v[56:57], v2 offset:20480
    ds_read_b64_tr_b16 v[58:59], v2 offset:21504
    ds_read_b64_tr_b16 v[60:61], v3 offset:20480
    ds_read_b64_tr_b16 v[62:63], v3 offset:21504
    v_xor_b32 v32, v29, v32
    v_xor_b32 v33, v29, v33
    v_xor_b32 v34, v29, v34
    v_xor_b32 v35, v29, v35
    v_mfma_f32_32x32x16_bf16 v[80:95], v[192:195], v[36:39], v[80:95]
    v_mfma_f32_32x32x16_bf16 v[96:111], v[192:195], v[40:43], v[96:111]
    v_mfma_f32_32x32x16_bf16 v[112:127], v[192:195], v[44:47], v[112:127]
    v_mfma_f32_32x32x16_bf16 v[64:79], v[192:195], v[32:35], v[64:79]
    s_waitcnt lgkmcnt(0)
    ds_read_b64_tr_b16 v[32:33], v2 offset:8192
    ds_read_b64_tr_b16 v[34:35], v2 offset:9216
    ds_read_b64_tr_b16 v[36:37], v3 offset:8192
    ds_read_b64_tr_b16 v[38:39], v3 offset:9216
    ds_read_b64_tr_b16 v[40:41], v2 offset:24576
    ds_read_b64_tr_b16 v[42:43], v2 offset:25600
    ds_read_b64_tr_b16 v[44:45], v3 offset:24576
    ds_read_b64_tr_b16 v[46:47], v3 offset:25600
    v_xor_b32 v48, v29, v48
    v_xor_b32 v49, v29, v49
    v_xor_b32 v50, v29, v50
    v_xor_b32 v51, v29, v51
    v_mfma_f32_32x32x16_bf16 v[80:95], v[196:199], v[52:55], v[80:95]
    v_mfma_f32_32x32x16_bf16 v[96:111], v[196:199], v[56:59], v[96:111]
    v_mfma_f32_32x32x16_bf16 v[112:127], v[196:199], v[60:63], v[112:127]
    v_mfma_f32_32x32x16_bf16 v[64:79], v[196:199], v[48:51], v[64:79]
    s_waitcnt lgkmcnt(0)
    ds_read_b64_tr_b16 v[48:49], v2 offset:12288
    ds_read_b64_tr_b16 v[50:51], v2 offset:13312
    ds_read_b64_tr_b16 v[52:53], v3 offset:12288
    ds_read_b64_tr_b16 v[54:55], v3 offset:13312
    ds_read_b64_tr_b16 v[56:57], v2 offset:28672
    ds_read_b64_tr_b16 v[58:59], v2 offset:29696
    ds_read_b64_tr_b16 v[60:61], v3 offset:28672
    ds_read_b64_tr_b16 v[62:63], v3 offset:29696
    v_xor_b32 v32, v29, v32
    v_xor_b32 v33, v29, v33
    v_xor_b32 v34, v29, v34
    v_xor_b32 v35, v29, v35
    v_mfma_f32_32x32x16_bf16 v[80:95], v[200:203], v[36:39], v[80:95]
    v_mfma_f32_32x32x16_bf16 v[96:111], v[200:203], v[40:43], v[96:111]
    v_mfma_f32_32x32x16_bf16 v[112:127], v[200:203], v[44:47], v[112:127]
    v_mfma_f32_32x32x16_bf16 v[64:79], v[200:203], v[32:35], v[64:79]
    s_waitcnt lgkmcnt(0)
    s_waitcnt vmcnt(8)
    s_barrier
    v_add_u32 v2, 32768, v27
    v_add_u32 v3, 32768, v28
    ds_read_b64_tr_b16 v[32:33], v2 offset:0
    ds_read_b64_tr_b16 v[34:35], v2 offset:1024
    ds_read_b64_tr_b16 v[36:37], v3 offset:0
    ds_read_b64_tr_b16 v[38:39], v3 offset:1024
    ds_read_b64_tr_b16 v[40:41], v2 offset:16384
    ds_read_b64_tr_b16 v[42:43], v2 offset:17408
    ds_read_b64_tr_b16 v[44:45], v3 offset:16384
    ds_read_b64_tr_b16 v[46:47], v3 offset:17408
    v_xor_b32 v48, v29, v48
    v_xor_b32 v49, v29, v49
    v_xor_b32 v50, v29, v50
    v_xor_b32 v51, v29, v51
    v_mfma_f32_32x32x16_bf16 v[80:95], v[204:207], v[52:55], v[80:95]
    v_mfma_f32_32x32x16_bf16 v[96:111], v[204:207], v[56:59], v[96:111]
    v_mfma_f32_32x32x16_bf16 v[112:127], v[204:207], v[60:63], v[112:127]
    v_mfma_f32_32x32x16_bf16 v[64:79], v[204:207], v[48:51], v[64:79]
    s_waitcnt lgkmcnt(0)
    ds_read_b64_tr_b16 v[48:49], v2 offset:4096
    ds_read_b64_tr_b16 v[50:51], v2 offset:5120
    ds_read_b64_tr_b16 v[52:53], v3 offset:4096
    ds_read_b64_tr_b16 v[54:55], v3 offset:5120
    ds_read_b64_tr_b16 v[56:57], v2 offset:20480
    ds_read_b64_tr_b16 v[58:59], v2 offset:21504
    ds_read_b64_tr_b16 v[60:61], v3 offset:20480
    ds_read_b64_tr_b16 v[62:63], v3 offset:21504
    buffer_load_ushort v16, v24, s[24:27], s30 offen offset:0
    v_xor_b32 v32, v29, v32
    v_xor_b32 v33, v29, v33
    v_xor_b32 v34, v29, v34
    v_xor_b32 v35, v29, v35
    v_mfma_f32_32x32x16_bf16 v[80:95], v[208:211], v[36:39], v[80:95]
    v_mfma_f32_32x32x16_bf16 v[96:111], v[208:211], v[40:43], v[96:111]
    v_mfma_f32_32x32x16_bf16 v[112:127], v[208:211], v[44:47], v[112:127]
    v_mfma_f32_32x32x16_bf16 v[64:79], v[208:211], v[32:35], v[64:79]
    s_waitcnt lgkmcnt(0)
    ds_read_b64_tr_b16 v[32:33], v2 offset:8192
    ds_read_b64_tr_b16 v[34:35], v2 offset:9216
    ds_read_b64_tr_b16 v[36:37], v3 offset:8192
    ds_read_b64_tr_b16 v[38:39], v3 offset:9216
    ds_read_b64_tr_b16 v[40:41], v2 offset:24576
    ds_read_b64_tr_b16 v[42:43], v2 offset:25600
    ds_read_b64_tr_b16 v[44:45], v3 offset:24576
    ds_read_b64_tr_b16 v[46:47], v3 offset:25600
    buffer_load_ushort v17, v24, s[24:27], s30 offen offset:1024
    v_xor_b32 v48, v29, v48
    v_xor_b32 v49, v29, v49
    v_xor_b32 v50, v29, v50
    v_xor_b32 v51, v29, v51
    v_mfma_f32_32x32x16_bf16 v[80:95], v[212:215], v[52:55], v[80:95]
    v_mfma_f32_32x32x16_bf16 v[96:111], v[212:215], v[56:59], v[96:111]
    v_mfma_f32_32x32x16_bf16 v[112:127], v[212:215], v[60:63], v[112:127]
    v_mfma_f32_32x32x16_bf16 v[64:79], v[212:215], v[48:51], v[64:79]
    s_waitcnt lgkmcnt(0)
    ds_read_b64_tr_b16 v[48:49], v2 offset:12288
    ds_read_b64_tr_b16 v[50:51], v2 offset:13312
    ds_read_b64_tr_b16 v[52:53], v3 offset:12288
    ds_read_b64_tr_b16 v[54:55], v3 offset:13312
    ds_read_b64_tr_b16 v[56:57], v2 offset:28672
    ds_read_b64_tr_b16 v[58:59], v2 offset:29696
    ds_read_b64_tr_b16 v[60:61], v3 offset:28672
    ds_read_b64_tr_b16 v[62:63], v3 offset:29696
    buffer_load_ushort v18, v24, s[24:27], s30 offen offset:2048
    v_xor_b32 v32, v29, v32
    v_xor_b32 v33, v29, v33
    v_xor_b32 v34, v29, v34
    v_xor_b32 v35, v29, v35
    v_mfma_f32_32x32x16_bf16 v[80:95], v[216:219], v[36:39], v[80:95]
    v_mfma_f32_32x32x16_bf16 v[96:111], v[216:219], v[40:43], v[96:111]
    v_mfma_f32_32x32x16_bf16 v[112:127], v[216:219], v[44:47], v[112:127]
    v_mfma_f32_32x32x16_bf16 v[64:79], v[216:219], v[32:35], v[64:79]
    s_waitcnt lgkmcnt(0)
    s_waitcnt vmcnt(7)
    s_barrier
    v_add_u32 v2, 98304, v27
    v_add_u32 v3, 98304, v28
    ds_read_b64_tr_b16 v[32:33], v2 offset:0
    ds_read_b64_tr_b16 v[34:35], v2 offset:1024
    ds_read_b64_tr_b16 v[36:37], v3 offset:0
    ds_read_b64_tr_b16 v[38:39], v3 offset:1024
    ds_read_b64_tr_b16 v[40:41], v2 offset:16384
    ds_read_b64_tr_b16 v[42:43], v2 offset:17408
    ds_read_b64_tr_b16 v[44:45], v3 offset:16384
    ds_read_b64_tr_b16 v[46:47], v3 offset:17408
    buffer_load_ushort v19, v24, s[24:27], s30 offen offset:3072
    v_xor_b32 v48, v29, v48
    v_xor_b32 v49, v29, v49
    v_xor_b32 v50, v29, v50
    v_xor_b32 v51, v29, v51
    v_mfma_f32_32x32x16_bf16 v[80:95], v[220:223], v[52:55], v[80:95]
    v_mfma_f32_32x32x16_bf16 v[96:111], v[220:223], v[56:59], v[96:111]
    v_mfma_f32_32x32x16_bf16 v[112:127], v[220:223], v[60:63], v[112:127]
    v_mfma_f32_32x32x16_bf16 v[64:79], v[220:223], v[48:51], v[64:79]
    s_waitcnt lgkmcnt(0)
    ds_read_b64_tr_b16 v[48:49], v2 offset:4096
    ds_read_b64_tr_b16 v[50:51], v2 offset:5120
    ds_read_b64_tr_b16 v[52:53], v3 offset:4096
    ds_read_b64_tr_b16 v[54:55], v3 offset:5120
    ds_read_b64_tr_b16 v[56:57], v2 offset:20480
    ds_read_b64_tr_b16 v[58:59], v2 offset:21504
    ds_read_b64_tr_b16 v[60:61], v3 offset:20480
    ds_read_b64_tr_b16 v[62:63], v3 offset:21504
    buffer_load_ushort v20, v24, s[24:27], s31 offen offset:0
    v_xor_b32 v32, v29, v32
    v_xor_b32 v33, v29, v33
    v_xor_b32 v34, v29, v34
    v_xor_b32 v35, v29, v35
    v_mfma_f32_32x32x16_bf16 v[80:95], v[224:227], v[36:39], v[80:95]
    v_mfma_f32_32x32x16_bf16 v[96:111], v[224:227], v[40:43], v[96:111]
    v_mfma_f32_32x32x16_bf16 v[112:127], v[224:227], v[44:47], v[112:127]
    v_mfma_f32_32x32x16_bf16 v[64:79], v[224:227], v[32:35], v[64:79]
    s_waitcnt lgkmcnt(0)
    ds_read_b64_tr_b16 v[32:33], v2 offset:8192
    ds_read_b64_tr_b16 v[34:35], v2 offset:9216
    ds_read_b64_tr_b16 v[36:37], v3 offset:8192
    ds_read_b64_tr_b16 v[38:39], v3 offset:9216
    ds_read_b64_tr_b16 v[40:41], v2 offset:24576
    ds_read_b64_tr_b16 v[42:43], v2 offset:25600
    ds_read_b64_tr_b16 v[44:45], v3 offset:24576
    ds_read_b64_tr_b16 v[46:47], v3 offset:25600
    buffer_load_ushort v21, v24, s[24:27], s31 offen offset:1024
    v_xor_b32 v48, v29, v48
    v_xor_b32 v49, v29, v49
    v_xor_b32 v50, v29, v50
    v_xor_b32 v51, v29, v51
    v_mfma_f32_32x32x16_bf16 v[80:95], v[228:231], v[52:55], v[80:95]
    v_mfma_f32_32x32x16_bf16 v[96:111], v[228:231], v[56:59], v[96:111]
    v_mfma_f32_32x32x16_bf16 v[112:127], v[228:231], v[60:63], v[112:127]
    v_mfma_f32_32x32x16_bf16 v[64:79], v[228:231], v[48:51], v[64:79]
    s_waitcnt lgkmcnt(0)
    ds_read_b64_tr_b16 v[48:49], v2 offset:12288
    ds_read_b64_tr_b16 v[50:51], v2 offset:13312
    ds_read_b64_tr_b16 v[52:53], v3 offset:12288
    ds_read_b64_tr_b16 v[54:55], v3 offset:13312
    ds_read_b64_tr_b16 v[56:57], v2 offset:28672
    ds_read_b64_tr_b16 v[58:59], v2 offset:29696
    ds_read_b64_tr_b16 v[60:61], v3 offset:28672
    ds_read_b64_tr_b16 v[62:63], v3 offset:29696
    buffer_load_ushort v22, v24, s[24:27], s31 offen offset:2048
    v_xor_b32 v32, v29, v32
    v_xor_b32 v33, v29, v33
    v_xor_b32 v34, v29, v34
    v_xor_b32 v35, v29, v35
    v_mfma_f32_32x32x16_bf16 v[80:95], v[232:235], v[36:39], v[80:95]
    v_mfma_f32_32x32x16_bf16 v[96:111], v[232:235], v[40:43], v[96:111]
    v_mfma_f32_32x32x16_bf16 v[112:127], v[232:235], v[44:47], v[112:127]
    v_mfma_f32_32x32x16_bf16 v[64:79], v[232:235], v[32:35], v[64:79]
    s_waitcnt lgkmcnt(0)
    s_waitcnt vmcnt(7)
    s_barrier
    v_add_u32 v2, 131072, v27
    v_add_u32 v3, 131072, v28
    ds_read_b64_tr_b16 v[32:33], v2 offset:0
    ds_read_b64_tr_b16 v[34:35], v2 offset:1024
    ds_read_b64_tr_b16 v[36:37], v3 offset:0
    ds_read_b64_tr_b16 v[38:39], v3 offset:1024
    ds_read_b64_tr_b16 v[40:41], v2 offset:16384
    ds_read_b64_tr_b16 v[42:43], v2 offset:17408
    ds_read_b64_tr_b16 v[44:45], v3 offset:16384
    ds_read_b64_tr_b16 v[46:47], v3 offset:17408
    buffer_load_ushort v23, v24, s[24:27], s31 offen offset:3072
    v_xor_b32 v48, v29, v48
    v_xor_b32 v49, v29, v49
    v_xor_b32 v50, v29, v50
    v_xor_b32 v51, v29, v51
    v_mfma_f32_32x32x16_bf16 v[80:95], v[236:239], v[52:55], v[80:95]
    v_mfma_f32_32x32x16_bf16 v[96:111], v[236:239], v[56:59], v[96:111]
    v_mfma_f32_32x32x16_bf16 v[112:127], v[236:239], v[60:63], v[112:127]
    v_mfma_f32_32x32x16_bf16 v[64:79], v[236:239], v[48:51], v[64:79]
    s_waitcnt lgkmcnt(0)
    ds_read_b64_tr_b16 v[48:49], v2 offset:4096
    ds_read_b64_tr_b16 v[50:51], v2 offset:5120
    ds_read_b64_tr_b16 v[52:53], v3 offset:4096
    ds_read_b64_tr_b16 v[54:55], v3 offset:5120
    ds_read_b64_tr_b16 v[56:57], v2 offset:20480
    ds_read_b64_tr_b16 v[58:59], v2 offset:21504
    ds_read_b64_tr_b16 v[60:61], v3 offset:20480
    ds_read_b64_tr_b16 v[62:63], v3 offset:21504
    v_xor_b32 v32, v29, v32
    v_xor_b32 v33, v29, v33
    v_xor_b32 v34, v29, v34
    v_xor_b32 v35, v29, v35
    v_mfma_f32_32x32x16_bf16 v[80:95], v[240:243], v[36:39], v[80:95]
    v_mfma_f32_32x32x16_bf16 v[96:111], v[240:243], v[40:43], v[96:111]
    v_mfma_f32_32x32x16_bf16 v[112:127], v[240:243], v[44:47], v[112:127]
    v_mfma_f32_32x32x16_bf16 v[64:79], v[240:243], v[32:35], v[64:79]
    s_waitcnt lgkmcnt(0)
    ds_read_b64_tr_b16 v[32:33], v2 offset:8192
    ds_read_b64_tr_b16 v[34:35], v2 offset:9216
    ds_read_b64_tr_b16 v[36:37], v3 offset:8192
    ds_read_b64_tr_b16 v[38:39], v3 offset:9216
    ds_read_b64_tr_b16 v[40:41], v2 offset:24576
    ds_read_b64_tr_b16 v[42:43], v2 offset:25600
    ds_read_b64_tr_b16 v[44:45], v3 offset:24576
    ds_read_b64_tr_b16 v[46:47], v3 offset:25600
    v_xor_b32 v48, v29, v48
    v_xor_b32 v49, v29, v49
    v_xor_b32 v50, v29, v50
    v_xor_b32 v51, v29, v51
    v_mfma_f32_32x32x16_bf16 v[80:95], v[244:247], v[52:55], v[80:95]
    v_mfma_f32_32x32x16_bf16 v[96:111], v[244:247], v[56:59], v[96:111]
    v_mfma_f32_32x32x16_bf16 v[112:127], v[244:247], v[60:63], v[112:127]
    v_mfma_f32_32x32x16_bf16 v[64:79], v[244:247], v[48:51], v[64:79]
    s_waitcnt lgkmcnt(0)
    ds_read_b64_tr_b16 v[48:49], v2 offset:12288
    ds_read_b64_tr_b16 v[50:51], v2 offset:13312
    ds_read_b64_tr_b16 v[52:53], v3 offset:12288
    ds_read_b64_tr_b16 v[54:55], v3 offset:13312
    ds_read_b64_tr_b16 v[56:57], v2 offset:28672
    ds_read_b64_tr_b16 v[58:59], v2 offset:29696
    ds_read_b64_tr_b16 v[60:61], v3 offset:28672
    ds_read_b64_tr_b16 v[62:63], v3 offset:29696
    v_xor_b32 v32, v29, v32
    v_xor_b32 v33, v29, v33
    v_xor_b32 v34, v29, v34
    v_xor_b32 v35, v29, v35
    v_mfma_f32_32x32x16_bf16 v[80:95], v[248:251], v[36:39], v[80:95]
    v_mfma_f32_32x32x16_bf16 v[96:111], v[248:251], v[40:43], v[96:111]
    v_mfma_f32_32x32x16_bf16 v[112:127], v[248:251], v[44:47], v[112:127]
    v_mfma_f32_32x32x16_bf16 v[64:79], v[248:251], v[32:35], v[64:79]
    s_waitcnt lgkmcnt(0)
    v_xor_b32 v48, v29, v48
    v_xor_b32 v49, v29, v49
    v_xor_b32 v50, v29, v50
    v_xor_b32 v51, v29, v51
    v_mfma_f32_32x32x16_bf16 v[80:95], v[252:255], v[52:55], v[80:95]
    v_mfma_f32_32x32x16_bf16 v[96:111], v[252:255], v[56:59], v[96:111]
    v_mfma_f32_32x32x16_bf16 v[112:127], v[252:255], v[60:63], v[112:127]
    v_mfma_f32_32x32x16_bf16 v[64:79], v[252:255], v[48:51], v[64:79]
    s_lshr_b32 s20, s72, 1
    s_lshl_b32 s21, s20, 19
    s_lshr_b32 s22, s58, 8
    s_lshl_b32 s22, s22, 2
    s_lshl_b32 s23, s73, 1
    s_add_u32 s22, s22, s23
    s_lshl_b32 s23, s22, 16
    s_add_u32 s21, s21, s23
    s_lshl_b32 s23, s5, 2
    s_and_b32 s24, s72, 1
    s_lshl_b32 s24, s24, 1
    s_add_u32 s23, s23, s24
    s_lshl_b32 s23, s23, 10
    s_add_u32 s21, s21, s23
    s_add_u32 s21, s21, 13369344
    s_add_u32 s25, s21, 65536
    s_waitcnt vmcnt(0)
    v_lshl_or_b32 v4, v17, 16, v16
    v_lshl_or_b32 v5, v19, 16, v18
    v_lshl_or_b32 v6, v21, 16, v20
    v_lshl_or_b32 v7, v23, 16, v22
    s_cmp_ge_u32 s2, 224
    s_cbranch_scc1 K1_NOWD_d
    buffer_store_dwordx4 v[4:7], v14, s[32:35], s66 offen sc0 sc1
K1_NOWD_d:
    s_nop 7
    s_nop 7
    s_lshl_b32 s24, s5, 2
    s_add_u32 s24, s24, s72
    s_cmp_eq_u32 s24, 2
    s_cbranch_scc0 K1_NO1024
    s_lshl_b32 s24, s22, 7
    s_add_u32 s24, s24, 14417920
    v_lshlrev_b32 v2, 2, v1
    v_cmp_gt_u32 vcc, 32, v1
    s_and_saveexec_b64 s[26:27], vcc
    buffer_store_dword v64, v2, s[32:35], s24 offen
    buffer_store_dword v80, v2, s[32:35], s24 offen offset:128
    s_mov_b64 exec, s[26:27]
K1_NO1024:
    s_cmp_eq_u32 s20, 0
    s_cbranch_scc1 K1_EP_AE
    v_mov_b32 v64, v96
    v_mov_b32 v65, v97
    v_mov_b32 v66, v98
    v_mov_b32 v67, v99
    v_mov_b32 v68, v100
    v_mov_b32 v69, v101
    v_mov_b32 v70, v102
    v_mov_b32 v71, v103
    v_mov_b32 v72, v104
    v_mov_b32 v73, v105
    v_mov_b32 v74, v106
    v_mov_b32 v75, v107
    v_mov_b32 v76, v108
    v_mov_b32 v77, v109
    v_mov_b32 v78, v110
    v_mov_b32 v79, v111
    v_mov_b32 v80, v112
    v_mov_b32 v81, v113
    v_mov_b32 v82, v114
    v_mov_b32 v83, v115
    v_mov_b32 v84, v116
    v_mov_b32 v85, v117
    v_mov_b32 v86, v118
    v_mov_b32 v87, v119
    v_mov_b32 v88, v120
    v_mov_b32 v89, v121
    v_mov_b32 v90, v122
    v_mov_b32 v91, v123
    v_mov_b32 v92, v124
    v_mov_b32 v93, v125
    v_mov_b32 v94, v126
    v_mov_b32 v95, v127
K1_EP_AE:
    v_cvt_pk_bf16_f32 v32, v64, v65
    v_cvt_pk_bf16_f32 v33, v66, v67
    v_cvt_pk_bf16_f32 v34, v68, v69
    v_cvt_pk_bf16_f32 v35, v70, v71
    v_cvt_pk_bf16_f32 v36, v72, v73
    v_cvt_pk_bf16_f32 v37, v74, v75
    v_cvt_pk_bf16_f32 v38, v76, v77
    v_cvt_pk_bf16_f32 v39, v78, v79
    buffer_store_dwordx4 v[32:35], v14, s[32:35], s21 offen sc0 sc1
    buffer_store_dwordx4 v[36:39], v14, s[32:35], s21 offen offset:1024 sc0 sc1
    v_cvt_pk_bf16_f32 v40, v80, v81
    v_cvt_pk_bf16_f32 v41, v82, v83
    v_cvt_pk_bf16_f32 v42, v84, v85
    v_cvt_pk_bf16_f32 v43, v86, v87
    v_cvt_pk_bf16_f32 v44, v88, v89
    v_cvt_pk_bf16_f32 v45, v90, v91
    v_cvt_pk_bf16_f32 v46, v92, v93
    v_cvt_pk_bf16_f32 v47, v94, v95
    buffer_store_dwordx4 v[40:43], v14, s[32:35], s25 offen sc0 sc1
    buffer_store_dwordx4 v[44:47], v14, s[32:35], s25 offen offset:1024 sc0 sc1
K1_END:
    s_endpgm
.globl fnet_k2_kernel
.p2align 8
.type fnet_k2_kernel,@function
fnet_k2_kernel:
    s_cmp_ge_u32 s2, 256
    s_cbranch_scc1 K2_END
    s_load_dwordx2 s[36:37], s[0:1], 0
    s_load_dwordx2 s[38:39], s[0:1], 72
    s_load_dwordx2 s[40:41], s[0:1], 88
    s_and_b32 s3, s2, 7
    s_lshr_b32 s4, s2, 3
    s_lshr_b32 s5, s3, 1
    s_lshl_b32 s5, s5, 3
    s_and_b32 s6, s4, 7
    s_add_u32 s5, s5, s6
    s_and_b32 s6, s3, 1
    s_lshl_b32 s6, s6, 2
    s_lshr_b32 s7, s4, 3
    s_add_u32 s6, s6, s7
    s_lshl_b32 s5, s3, 2
    s_and_b32 s6, s4, 3
    s_add_u32 s5, s5, s6
    s_lshr_b32 s6, s4, 2
    v_and_b32 v1, 63, v0
    v_lshrrev_b32 v2, 6, v0
    s_nop 0
    v_readfirstlane_b32 s7, v2
    v_lshlrev_b32 v3, 4, v1
    v_and_b32 v4, 31, v1
    v_lshrrev_b32 v5, 5, v1
    s_mul_i32 s44, s5, 229376
    s_mul_i32 s20, s7, 28672
    s_add_u32 s44, s44, s20
    s_add_u32 s45, s44, 114688
    s_mul_i32 s46, s6, 229376
    s_add_u32 s46, s46, s20
    s_add_u32 s46, s46, 7340032
    s_add_u32 s47, s46, 114688
    s_lshl_b32 s21, s7, 14
    s_lshl_b32 s49, s6, 16
    s_add_u32 s49, s49, s21
    s_add_u32 s49, s49, 13369344
    s_add_u32 s51, s49, 524288
    s_and_b32 s52, s4, 7
    s_lshr_b32 s53, s4, 3
    s_lshl_b32 s53, s53, 1
    s_add_u32 s52, s52, s53
    s_cmp_ge_u32 s52, 7
    s_cselect_b32 s53, 7, 0
    s_sub_u32 s52, s52, s53
    s_cmp_ge_u32 s52, 7
    s_cselect_b32 s53, 7, 0
    s_sub_u32 s52, s52, s53
    s_mov_b32 s52, 0
    s_lshl_b32 s53, s52, 12
    s_add_u32 s44, s44, s53
    s_add_u32 s45, s45, s53
    s_add_u32 s46, s46, s53
    s_add_u32 s47, s47, s53
    s_mov_b32 s54, 4096
    s_waitcnt lgkmcnt(0)
    s_mov_b32 s8, s40
    s_and_b32 s9, s41, 0xffff
    s_mov_b32 s10, 0xdc0400
    s_mov_b32 s11, 0x20000
    s_mov_b32 s12, s36
    s_and_b32 s13, s37, 0xffff
    s_mov_b32 s14, 0x200000
    s_mov_b32 s15, 0x20000
    s_mov_b32 s16, s38
    s_and_b32 s17, s39, 0xffff
    s_mov_b32 s18, 0x200000
    s_mov_b32 s19, 0x20000
    buffer_load_dwordx4 v[64:67], v3, s[8:11], s44 offen offset:0
    buffer_load_dwordx4 v[68:71], v3, s[8:11], s45 offen offset:0
    buffer_load_dwordx4 v[72:75], v3, s[8:11], s46 offen offset:0
    buffer_load_dwordx4 v[76:79], v3, s[8:11], s47 offen offset:0
    buffer_load_dwordx4 v[80:83], v3, s[8:11], s49 offen offset:0
    buffer_load_dwordx4 v[84:87], v3, s[8:11], s51 offen offset:0
    buffer_load_dwordx4 v[96:99], v3, s[8:11], s44 offen offset:1024
    buffer_load_dwordx4 v[100:103], v3, s[8:11], s45 offen offset:1024
    buffer_load_dwordx4 v[104:107], v3, s[8:11], s46 offen offset:1024
    buffer_load_dwordx4 v[108:111], v3, s[8:11], s47 offen offset:1024
    buffer_load_dwordx4 v[112:115], v3, s[8:11], s44 offen offset:2048
    buffer_load_dwordx4 v[116:119], v3, s[8:11], s45 offen offset:2048
    buffer_load_dwordx4 v[120:123], v3, s[8:11], s46 offen offset:2048
    buffer_load_dwordx4 v[124:127], v3, s[8:11], s47 offen offset:2048
    buffer_load_dwordx4 v[128:131], v3, s[8:11], s49 offen offset:1024
    buffer_load_dwordx4 v[132:135], v3, s[8:11], s51 offen offset:1024
    buffer_load_dwordx4 v[144:147], v3, s[8:11], s44 offen offset:3072
    buffer_load_dwordx4 v[148:151], v3, s[8:11], s45 offen offset:3072
    buffer_load_dwordx4 v[152:155], v3, s[8:11], s46 offen offset:3072
    buffer_load_dwordx4 v[156:159], v3, s[8:11], s47 offen offset:3072
    s_cmp_eq_u32 s52, 6
    s_cselect_b32 s55, -24576, s54
    s_add_u32 s44, s44, s55
    s_add_u32 s45, s45, s55
    s_add_u32 s46, s46, s55
    s_add_u32 s47, s47, s55
    buffer_load_dwordx4 v[160:163], v3, s[8:11], s44 offen offset:0
    buffer_load_dwordx4 v[164:167], v3, s[8:11], s45 offen offset:0
    buffer_load_dwordx4 v[168:171], v3, s[8:11], s46 offen offset:0
    buffer_load_dwordx4 v[172:175], v3, s[8:11], s47 offen offset:0
    buffer_load_dwordx4 v[176:179], v3, s[8:11], s49 offen offset:2048
    buffer_load_dwordx4 v[180:183], v3, s[8:11], s51 offen offset:2048
    buffer_load_dwordx4 v[192:195], v3, s[8:11], s44 offen offset:1024
    buffer_load_dwordx4 v[196:199], v3, s[8:11], s45 offen offset:1024
    buffer_load_dwordx4 v[200:203], v3, s[8:11], s46 offen offset:1024
    buffer_load_dwordx4 v[204:207], v3, s[8:11], s47 offen offset:1024
    buffer_load_dwordx4 v[208:211], v3, s[8:11], s49 offen offset:3072
    buffer_load_dwordx4 v[212:215], v3, s[8:11], s51 offen offset:3072
    s_add_u32 s49, s49, 4096
    s_add_u32 s51, s51, 4096
    buffer_load_dwordx4 v[224:227], v3, s[8:11], s44 offen offset:2048
    buffer_load_dwordx4 v[228:231], v3, s[8:11], s45 offen offset:2048
    buffer_load_dwordx4 v[232:235], v3, s[8:11], s46 offen offset:2048
    buffer_load_dwordx4 v[236:239], v3, s[8:11], s47 offen offset:2048
    buffer_load_dwordx4 v[240:243], v3, s[8:11], s44 offen offset:3072
    buffer_load_dwordx4 v[244:247], v3, s[8:11], s45 offen offset:3072
    buffer_load_dwordx4 v[248:251], v3, s[8:11], s46 offen offset:3072
    buffer_load_dwordx4 v[252:255], v3, s[8:11], s47 offen offset:3072
    s_cmp_eq_u32 s52, 5
    s_cselect_b32 s55, -24576, s54
    s_add_u32 s44, s44, s55
    s_add_u32 s45, s45, s55
    s_add_u32 s46, s46, s55
    s_add_u32 s47, s47, s55
    s_lshr_b32 s22, s7, 1
    s_and_b32 s23, s7, 1
    s_lshl_b32 s24, s5, 5
    v_lshl_add_u32 v6, v5, 2, s24
    s_lshl_b32 s24, s6, 5
    v_add_u32 v7, s24, v4
    s_cmp_eq_u32 s23, 0
    s_cbranch_scc1 K2_COLA
    v_sub_u32 v7, 0x200, v7
    v_cmp_eq_u32 vcc, 0x200, v7
    v_mov_b32 v8, 0x100
    s_nop 0
    v_cndmask_b32 v7, v7, v8, vcc
K2_COLA:
    s_mov_b32 s25, 1024
    s_cmp_eq_u32 s22, 0
    s_cbranch_scc1 K2_ROWA
    v_sub_u32 v6, 0x800, v6
    s_mov_b32 s25, -1024
K2_ROWA:
    v_lshlrev_b32 v6, 10, v6
    v_lshl_add_u32 v6, v7, 1, v6
    v_mov_b32 v8, 0
    v_mad_i32_i24 v16, v8, s25, v6
    v_mov_b32 v8, 1
    v_mad_i32_i24 v17, v8, s25, v6
    v_mov_b32 v8, 2
    v_mad_i32_i24 v18, v8, s25, v6
    v_mov_b32 v8, 3
    v_mad_i32_i24 v19, v8, s25, v6
    v_mov_b32 v8, 8
    v_mad_i32_i24 v20, v8, s25, v6
    v_mov_b32 v8, 9
    v_mad_i32_i24 v21, v8, s25, v6
    v_mov_b32 v8, 10
    v_mad_i32_i24 v22, v8, s25, v6
    v_mov_b32 v8, 11
    v_mad_i32_i24 v23, v8, s25, v6
    v_mov_b32 v8, 16
    v_mad_i32_i24 v24, v8, s25, v6
    v_mov_b32 v8, 17
    v_mad_i32_i24 v25, v8, s25, v6
    v_mov_b32 v8, 18
    v_mad_i32_i24 v26, v8, s25, v6
    v_mov_b32 v8, 19
    v_mad_i32_i24 v27, v8, s25, v6
    v_mov_b32 v8, 24
    v_mad_i32_i24 v28, v8, s25, v6
    v_mov_b32 v8, 25
    v_mad_i32_i24 v29, v8, s25, v6
    v_mov_b32 v8, 26
    v_mad_i32_i24 v30, v8, s25, v6
    v_mov_b32 v8, 27
    v_mad_i32_i24 v31, v8, s25, v6
    v_cmp_le_u32 vcc, 0x200000, v16
    v_subrev_u32 v8, 0x100000, v16
    s_nop 0
    v_cndmask_b32 v16, v16, v8, vcc
    s_mov_b64 s[30:31], vcc
    buffer_load_ushort v32, v16, s[12:15], 0 offen
    buffer_load_ushort v33, v17, s[12:15], 0 offen
    buffer_load_ushort v34, v18, s[12:15], 0 offen
    buffer_load_ushort v35, v19, s[12:15], 0 offen
    buffer_load_ushort v36, v20, s[12:15], 0 offen
    buffer_load_ushort v37, v21, s[12:15], 0 offen
    buffer_load_ushort v38, v22, s[12:15], 0 offen
    buffer_load_ushort v39, v23, s[12:15], 0 offen
    buffer_load_ushort v40, v24, s[12:15], 0 offen
    buffer_load_ushort v41, v25, s[12:15], 0 offen
    buffer_load_ushort v42, v26, s[12:15], 0 offen
    buffer_load_ushort v43, v27, s[12:15], 0 offen
    buffer_load_ushort v44, v28, s[12:15], 0 offen
    buffer_load_ushort v45, v29, s[12:15], 0 offen
    buffer_load_ushort v46, v30, s[12:15], 0 offen
    buffer_load_ushort v47, v31, s[12:15], 0 offen
    s_lshl_b32 s24, s6, 7
    s_add_u32 s24, s24, 14417920
    v_lshlrev_b32 v8, 2, v4
    buffer_load_dword v9, v8, s[8:11], s24 offen
    v_mov_b32 v12, 0xbf803f80
    v_mov_b32 v13, v12
    v_mov_b32 v14, v12
    v_mov_b32 v15, v12
    s_lshl_b32 s24, s5, 5
    v_add_u32 v2, s24, v4
    v_cvt_f32_u32 v2, v2
    v_mul_f32 v2, 0x3a000000, v2
    s_lshl_b32 s24, s7, 8
    v_lshl_add_u32 v6, v5, 2, s24
    v_add_u32 v7, 0, v6
    v_cvt_f32_u32 v7, v7
    v_mul_f32 v48, v2, v7
    v_fract_f32 v48, v48
    v_add_u32 v7, 1, v6
    v_cvt_f32_u32 v7, v7
    v_mul_f32 v49, v2, v7
    v_fract_f32 v49, v49
    v_add_u32 v7, 2, v6
    v_cvt_f32_u32 v7, v7
    v_mul_f32 v50, v2, v7
    v_fract_f32 v50, v50
    v_add_u32 v7, 3, v6
    v_cvt_f32_u32 v7, v7
    v_mul_f32 v51, v2, v7
    v_fract_f32 v51, v51
    v_add_u32 v7, 8, v6
    v_cvt_f32_u32 v7, v7
    v_mul_f32 v52, v2, v7
    v_fract_f32 v52, v52
    v_add_u32 v7, 9, v6
    v_cvt_f32_u32 v7, v7
    v_mul_f32 v53, v2, v7
    v_fract_f32 v53, v53
    v_add_u32 v7, 10, v6
    v_cvt_f32_u32 v7, v7
    v_mul_f32 v54, v2, v7
    v_fract_f32 v54, v54
    v_add_u32 v7, 11, v6
    v_cvt_f32_u32 v7, v7
    v_mul_f32 v55, v2, v7
    v_fract_f32 v55, v55
    v_mul_f32 v11, 0x41800000, v2
    v_fract_f32 v11, v11
    v_cos_f32 v2, v48
    v_cos_f32 v6, v49
    v_cos_f32 v7, v50
    v_cos_f32 v8, v51
    v_sin_f32_e64 v10, -v48
    v_cvt_pk_bf16_f32 v56, v2, v6
    v_cvt_pk_bf16_f32 v57, v7, v8
    v_sin_f32_e64 v6, -v49
    v_sin_f32_e64 v7, -v50
    v_sin_f32_e64 v8, -v51
    v_add_f32 v48, v11, v48
    v_cvt_pk_bf16_f32 v60, v10, v6
    v_cvt_pk_bf16_f32 v61, v7, v8
    v_add_f32 v49, v11, v49
    v_add_f32 v50, v11, v50
    v_add_f32 v51, v11, v51
    v_fract_f32 v48, v48
    v_fract_f32 v49, v49
    v_fract_f32 v50, v50
    v_fract_f32 v51, v51
    v_cos_f32 v2, v52
    v_cos_f32 v6, v53
    v_cos_f32 v7, v54
    v_cos_f32 v8, v55
    v_sin_f32_e64 v10, -v52
    v_cvt_pk_bf16_f32 v58, v2, v6
    v_cvt_pk_bf16_f32 v59, v7, v8
    v_sin_f32_e64 v6, -v53
    v_sin_f32_e64 v7, -v54
    v_sin_f32_e64 v8, -v55
    v_add_f32 v52, v11, v52
    v_cvt_pk_bf16_f32 v62, v10, v6
    v_cvt_pk_bf16_f32 v63, v7, v8
    v_add_f32 v53, v11, v53
    v_add_f32 v54, v11, v54
    v_add_f32 v55, v11, v55
    v_fract_f32 v52, v52
    v_fract_f32 v53, v53
    v_fract_f32 v54, v54
    v_fract_f32 v55, v55
    s_waitcnt vmcnt(53)
    v_mfma_f32_32x32x16_bf16 a[0:15], v[64:67], v[72:75], 0
    v_mfma_f32_32x32x16_bf16 a[16:31], v[64:67], v[76:79], 0
    v_mfma_f32_32x32x16_bf16 a[32:47], v[68:71], v[72:75], 0
    v_mfma_f32_32x32x16_bf16 a[48:63], v[68:71], v[76:79], 0
    buffer_load_dwordx4 v[64:67], v3, s[8:11], s49 offen offset:0
    buffer_load_dwordx4 v[68:71], v3, s[8:11], s51 offen offset:0
    s_waitcnt vmcnt(53)
    v_mfma_f32_32x32x16_bf16 a[64:79], v[56:59], v[80:83], 0
    v_mfma_f32_32x32x16_bf16 a[80:95], v[60:63], v[84:87], 0
    v_mfma_f32_32x32x16_bf16 a[96:111], v[12:15], v[80:83], 0
    buffer_load_dwordx4 v[80:83], v3, s[8:11], s44 offen offset:0
    buffer_load_dwordx4 v[84:87], v3, s[8:11], s45 offen offset:0
    buffer_load_dwordx4 v[88:91], v3, s[8:11], s46 offen offset:0
    buffer_load_dwordx4 v[92:95], v3, s[8:11], s47 offen offset:0
    v_cos_f32 v2, v48
    v_cos_f32 v6, v49
    v_cos_f32 v7, v50
    v_cos_f32 v8, v51
    v_sin_f32_e64 v10, -v48
    v_cvt_pk_bf16_f32 v56, v2, v6
    v_cvt_pk_bf16_f32 v57, v7, v8
    v_sin_f32_e64 v6, -v49
    v_sin_f32_e64 v7, -v50
    v_sin_f32_e64 v8, -v51
    v_add_f32 v48, v11, v48
    v_cvt_pk_bf16_f32 v60, v10, v6
    v_cvt_pk_bf16_f32 v61, v7, v8
    v_add_f32 v49, v11, v49
    v_add_f32 v50, v11, v50
    v_add_f32 v51, v11, v51
    v_fract_f32 v48, v48
    v_fract_f32 v49, v49
    v_fract_f32 v50, v50
    v_fract_f32 v51, v51
    v_cos_f32 v2, v52
    v_cos_f32 v6, v53
    v_cos_f32 v7, v54
    v_cos_f32 v8, v55
    v_sin_f32_e64 v10, -v52
    v_cvt_pk_bf16_f32 v58, v2, v6
    v_cvt_pk_bf16_f32 v59, v7, v8
    v_sin_f32_e64 v6, -v53
    v_sin_f32_e64 v7, -v54
    v_sin_f32_e64 v8, -v55
    v_add_f32 v52, v11, v52
    v_cvt_pk_bf16_f32 v62, v10, v6
    v_cvt_pk_bf16_f32 v63, v7, v8
    v_add_f32 v53, v11, v53
    v_add_f32 v54, v11, v54
    v_add_f32 v55, v11, v55
    v_fract_f32 v52, v52
    v_fract_f32 v53, v53
    v_fract_f32 v54, v54
    v_fract_f32 v55, v55
    s_waitcnt vmcnt(53)
    v_mfma_f32_32x32x16_bf16 a[0:15], v[96:99], v[104:107], a[0:15]
    v_mfma_f32_32x32x16_bf16 a[16:31], v[96:99], v[108:111], a[16:31]
    v_mfma_f32_32x32x16_bf16 a[32:47], v[100:103], v[104:107], a[32:47]
    v_mfma_f32_32x32x16_bf16 a[48:63], v[100:103], v[108:111], a[48:63]
    buffer_load_dwordx4 v[96:99], v3, s[8:11], s44 offen offset:1024
    buffer_load_dwordx4 v[100:103], v3, s[8:11], s45 offen offset:1024
    buffer_load_dwordx4 v[104:107], v3, s[8:11], s46 offen offset:1024
    buffer_load_dwordx4 v[108:111], v3, s[8:11], s47 offen offset:1024
    s_waitcnt vmcnt(53)
    v_mfma_f32_32x32x16_bf16 a[0:15], v[112:115], v[120:123], a[0:15]
    v_mfma_f32_32x32x16_bf16 a[16:31], v[112:115], v[124:127], a[16:31]
    v_mfma_f32_32x32x16_bf16 a[32:47], v[116:119], v[120:123], a[32:47]
    v_mfma_f32_32x32x16_bf16 a[48:63], v[116:119], v[124:127], a[48:63]
    buffer_load_dwordx4 v[112:115], v3, s[8:11], s49 offen offset:1024
    buffer_load_dwordx4 v[116:119], v3, s[8:11], s51 offen offset:1024
    s_waitcnt vmcnt(53)
    v_mfma_f32_32x32x16_bf16 a[64:79], v[56:59], v[128:131], a[64:79]
    v_mfma_f32_32x32x16_bf16 a[80:95], v[60:63], v[132:135], a[80:95]
    v_mfma_f32_32x32x16_bf16 a[96:111], v[12:15], v[128:131], a[96:111]
    buffer_load_dwordx4 v[128:131], v3, s[8:11], s44 offen offset:2048
    buffer_load_dwordx4 v[132:135], v3, s[8:11], s45 offen offset:2048
    buffer_load_dwordx4 v[136:139], v3, s[8:11], s46 offen offset:2048
    buffer_load_dwordx4 v[140:143], v3, s[8:11], s47 offen offset:2048
    v_cos_f32 v2, v48
    v_cos_f32 v6, v49
    v_cos_f32 v7, v50
    v_cos_f32 v8, v51
    v_sin_f32_e64 v10, -v48
    v_cvt_pk_bf16_f32 v56, v2, v6
    v_cvt_pk_bf16_f32 v57, v7, v8
    v_sin_f32_e64 v6, -v49
    v_sin_f32_e64 v7, -v50
    v_sin_f32_e64 v8, -v51
    v_add_f32 v48, v11, v48
    v_cvt_pk_bf16_f32 v60, v10, v6
    v_cvt_pk_bf16_f32 v61, v7, v8
    v_add_f32 v49, v11, v49
    v_add_f32 v50, v11, v50
    v_add_f32 v51, v11, v51
    v_fract_f32 v48, v48
    v_fract_f32 v49, v49
    v_fract_f32 v50, v50
    v_fract_f32 v51, v51
    v_cos_f32 v2, v52
    v_cos_f32 v6, v53
    v_cos_f32 v7, v54
    v_cos_f32 v8, v55
    v_sin_f32_e64 v10, -v52
    v_cvt_pk_bf16_f32 v58, v2, v6
    v_cvt_pk_bf16_f32 v59, v7, v8
    v_sin_f32_e64 v6, -v53
    v_sin_f32_e64 v7, -v54
    v_sin_f32_e64 v8, -v55
    v_add_f32 v52, v11, v52
    v_cvt_pk_bf16_f32 v62, v10, v6
    v_cvt_pk_bf16_f32 v63, v7, v8
    v_add_f32 v53, v11, v53
    v_add_f32 v54, v11, v54
    v_add_f32 v55, v11, v55
    v_fract_f32 v52, v52
    v_fract_f32 v53, v53
    v_fract_f32 v54, v54
    v_fract_f32 v55, v55
    s_waitcnt vmcnt(53)
    v_mfma_f32_32x32x16_bf16 a[0:15], v[144:147], v[152:155], a[0:15]
    v_mfma_f32_32x32x16_bf16 a[16:31], v[144:147], v[156:159], a[16:31]
    v_mfma_f32_32x32x16_bf16 a[32:47], v[148:151], v[152:155], a[32:47]
    v_mfma_f32_32x32x16_bf16 a[48:63], v[148:151], v[156:159], a[48:63]
    buffer_load_dwordx4 v[144:147], v3, s[8:11], s44 offen offset:3072
    buffer_load_dwordx4 v[148:151], v3, s[8:11], s45 offen offset:3072
    buffer_load_dwordx4 v[152:155], v3, s[8:11], s46 offen offset:3072
    buffer_load_dwordx4 v[156:159], v3, s[8:11], s47 offen offset:3072
    s_cmp_eq_u32 s52, 4
    s_cselect_b32 s55, -24576, s54
    s_add_u32 s44, s44, s55
    s_add_u32 s45, s45, s55
    s_add_u32 s46, s46, s55
    s_add_u32 s47, s47, s55
    s_waitcnt vmcnt(53)
    v_mfma_f32_32x32x16_bf16 a[0:15], v[160:163], v[168:171], a[0:15]
    v_mfma_f32_32x32x16_bf16 a[16:31], v[160:163], v[172:175], a[16:31]
    v_mfma_f32_32x32x16_bf16 a[32:47], v[164:167], v[168:171], a[32:47]
    v_mfma_f32_32x32x16_bf16 a[48:63], v[164:167], v[172:175], a[48:63]
    buffer_load_dwordx4 v[160:163], v3, s[8:11], s49 offen offset:2048
    buffer_load_dwordx4 v[164:167], v3, s[8:11], s51 offen offset:2048
    s_waitcnt vmcnt(53)
    v_mfma_f32_32x32x16_bf16 a[64:79], v[56:59], v[176:179], a[64:79]
    v_mfma_f32_32x32x16_bf16 a[80:95], v[60:63], v[180:183], a[80:95]
    v_mfma_f32_32x32x16_bf16 a[96:111], v[12:15], v[176:179], a[96:111]
    buffer_load_dwordx4 v[176:179], v3, s[8:11], s44 offen offset:0
    buffer_load_dwordx4 v[180:183], v3, s[8:11], s45 offen offset:0
    buffer_load_dwordx4 v[184:187], v3, s[8:11], s46 offen offset:0
    buffer_load_dwordx4 v[188:191], v3, s[8:11], s47 offen offset:0
    v_cos_f32 v2, v48
    v_cos_f32 v6, v49
    v_cos_f32 v7, v50
    v_cos_f32 v8, v51
    v_sin_f32_e64 v10, -v48
    v_cvt_pk_bf16_f32 v56, v2, v6
    v_cvt_pk_bf16_f32 v57, v7, v8
    v_sin_f32_e64 v6, -v49
    v_sin_f32_e64 v7, -v50
    v_sin_f32_e64 v8, -v51
    v_add_f32 v48, v11, v48
    v_cvt_pk_bf16_f32 v60, v10, v6
    v_cvt_pk_bf16_f32 v61, v7, v8
    v_add_f32 v49, v11, v49
    v_add_f32 v50, v11, v50
    v_add_f32 v51, v11, v51
    v_fract_f32 v48, v48
    v_fract_f32 v49, v49
    v_fract_f32 v50, v50
    v_fract_f32 v51, v51
    v_cos_f32 v2, v52
    v_cos_f32 v6, v53
    v_cos_f32 v7, v54
    v_cos_f32 v8, v55
    v_sin_f32_e64 v10, -v52
    v_cvt_pk_bf16_f32 v58, v2, v6
    v_cvt_pk_bf16_f32 v59, v7, v8
    v_sin_f32_e64 v6, -v53
    v_sin_f32_e64 v7, -v54
    v_sin_f32_e64 v8, -v55
    v_add_f32 v52, v11, v52
    v_cvt_pk_bf16_f32 v62, v10, v6
    v_cvt_pk_bf16_f32 v63, v7, v8
    v_add_f32 v53, v11, v53
    v_add_f32 v54, v11, v54
    v_add_f32 v55, v11, v55
    v_fract_f32 v52, v52
    v_fract_f32 v53, v53
    v_fract_f32 v54, v54
    v_fract_f32 v55, v55
    s_waitcnt vmcnt(53)
    v_mfma_f32_32x32x16_bf16 a[0:15], v[192:195], v[200:203], a[0:15]
    v_mfma_f32_32x32x16_bf16 a[16:31], v[192:195], v[204:207], a[16:31]
    v_mfma_f32_32x32x16_bf16 a[32:47], v[196:199], v[200:203], a[32:47]
    v_mfma_f32_32x32x16_bf16 a[48:63], v[196:199], v[204:207], a[48:63]
    buffer_load_dwordx4 v[192:195], v3, s[8:11], s49 offen offset:3072
    buffer_load_dwordx4 v[196:199], v3, s[8:11], s51 offen offset:3072
    s_add_u32 s49, s49, 4096
    s_add_u32 s51, s51, 4096
    s_waitcnt vmcnt(53)
    v_mfma_f32_32x32x16_bf16 a[64:79], v[56:59], v[208:211], a[64:79]
    v_mfma_f32_32x32x16_bf16 a[80:95], v[60:63], v[212:215], a[80:95]
    v_mfma_f32_32x32x16_bf16 a[96:111], v[12:15], v[208:211], a[96:111]
    buffer_load_dwordx4 v[208:211], v3, s[8:11], s44 offen offset:1024
    buffer_load_dwordx4 v[212:215], v3, s[8:11], s45 offen offset:1024
    buffer_load_dwordx4 v[216:219], v3, s[8:11], s46 offen offset:1024
    buffer_load_dwordx4 v[220:223], v3, s[8:11], s47 offen offset:1024
    v_cos_f32 v2, v48
    v_cos_f32 v6, v49
    v_cos_f32 v7, v50
    v_cos_f32 v8, v51
    v_sin_f32_e64 v10, -v48
    v_cvt_pk_bf16_f32 v56, v2, v6
    v_cvt_pk_bf16_f32 v57, v7, v8
    v_sin_f32_e64 v6, -v49
    v_sin_f32_e64 v7, -v50
    v_sin_f32_e64 v8, -v51
    v_add_f32 v48, v11, v48
    v_cvt_pk_bf16_f32 v60, v10, v6
    v_cvt_pk_bf16_f32 v61, v7, v8
    v_add_f32 v49, v11, v49
    v_add_f32 v50, v11, v50
    v_add_f32 v51, v11, v51
    v_fract_f32 v48, v48
    v_fract_f32 v49, v49
    v_fract_f32 v50, v50
    v_fract_f32 v51, v51
    v_cos_f32 v2, v52
    v_cos_f32 v6, v53
    v_cos_f32 v7, v54
    v_cos_f32 v8, v55
    v_sin_f32_e64 v10, -v52
    v_cvt_pk_bf16_f32 v58, v2, v6
    v_cvt_pk_bf16_f32 v59, v7, v8
    v_sin_f32_e64 v6, -v53
    v_sin_f32_e64 v7, -v54
    v_sin_f32_e64 v8, -v55
    v_add_f32 v52, v11, v52
    v_cvt_pk_bf16_f32 v62, v10, v6
    v_cvt_pk_bf16_f32 v63, v7, v8
    v_add_f32 v53, v11, v53
    v_add_f32 v54, v11, v54
    v_add_f32 v55, v11, v55
    v_fract_f32 v52, v52
    v_fract_f32 v53, v53
    v_fract_f32 v54, v54
    v_fract_f32 v55, v55
    s_waitcnt vmcnt(53)
    v_mfma_f32_32x32x16_bf16 a[0:15], v[224:227], v[232:235], a[0:15]
    v_mfma_f32_32x32x16_bf16 a[16:31], v[224:227], v[236:239], a[16:31]
    v_mfma_f32_32x32x16_bf16 a[32:47], v[228:231], v[232:235], a[32:47]
    v_mfma_f32_32x32x16_bf16 a[48:63], v[228:231], v[236:239], a[48:63]
    buffer_load_dwordx4 v[224:227], v3, s[8:11], s44 offen offset:2048
    buffer_load_dwordx4 v[228:231], v3, s[8:11], s45 offen offset:2048
    buffer_load_dwordx4 v[232:235], v3, s[8:11], s46 offen offset:2048
    buffer_load_dwordx4 v[236:239], v3, s[8:11], s47 offen offset:2048
    s_waitcnt vmcnt(53)
    v_mfma_f32_32x32x16_bf16 a[0:15], v[240:243], v[248:251], a[0:15]
    v_mfma_f32_32x32x16_bf16 a[16:31], v[240:243], v[252:255], a[16:31]
    v_mfma_f32_32x32x16_bf16 a[32:47], v[244:247], v[248:251], a[32:47]
    v_mfma_f32_32x32x16_bf16 a[48:63], v[244:247], v[252:255], a[48:63]
    buffer_load_dwordx4 v[240:243], v3, s[8:11], s49 offen offset:0
    buffer_load_dwordx4 v[244:247], v3, s[8:11], s51 offen offset:0
    s_waitcnt vmcnt(36)
    v_mfma_f32_32x32x16_bf16 a[64:79], v[56:59], v[64:67], a[64:79]
    v_mfma_f32_32x32x16_bf16 a[80:95], v[60:63], v[68:71], a[80:95]
    v_mfma_f32_32x32x16_bf16 a[96:111], v[12:15], v[64:67], a[96:111]
    buffer_load_dwordx4 v[64:67], v3, s[8:11], s44 offen offset:3072
    buffer_load_dwordx4 v[68:71], v3, s[8:11], s45 offen offset:3072
    buffer_load_dwordx4 v[72:75], v3, s[8:11], s46 offen offset:3072
    buffer_load_dwordx4 v[76:79], v3, s[8:11], s47 offen offset:3072
    s_cmp_eq_u32 s52, 3
    s_cselect_b32 s55, -24576, s54
    s_add_u32 s44, s44, s55
    s_add_u32 s45, s45, s55
    s_add_u32 s46, s46, s55
    s_add_u32 s47, s47, s55
    v_cos_f32 v2, v48
    v_cos_f32 v6, v49
    v_cos_f32 v7, v50
    v_cos_f32 v8, v51
    v_sin_f32_e64 v10, -v48
    v_cvt_pk_bf16_f32 v56, v2, v6
    v_cvt_pk_bf16_f32 v57, v7, v8
    v_sin_f32_e64 v6, -v49
    v_sin_f32_e64 v7, -v50
    v_sin_f32_e64 v8, -v51
    v_add_f32 v48, v11, v48
    v_cvt_pk_bf16_f32 v60, v10, v6
    v_cvt_pk_bf16_f32 v61, v7, v8
    v_add_f32 v49, v11, v49
    v_add_f32 v50, v11, v50
    v_add_f32 v51, v11, v51
    v_fract_f32 v48, v48
    v_fract_f32 v49, v49
    v_fract_f32 v50, v50
    v_fract_f32 v51, v51
    v_cos_f32 v2, v52
    v_cos_f32 v6, v53
    v_cos_f32 v7, v54
    v_cos_f32 v8, v55
    v_sin_f32_e64 v10, -v52
    v_cvt_pk_bf16_f32 v58, v2, v6
    v_cvt_pk_bf16_f32 v59, v7, v8
    v_sin_f32_e64 v6, -v53
    v_sin_f32_e64 v7, -v54
    v_sin_f32_e64 v8, -v55
    v_add_f32 v52, v11, v52
    v_cvt_pk_bf16_f32 v62, v10, v6
    v_cvt_pk_bf16_f32 v63, v7, v8
    v_add_f32 v53, v11, v53
    v_add_f32 v54, v11, v54
    v_add_f32 v55, v11, v55
    v_fract_f32 v52, v52
    v_fract_f32 v53, v53
    v_fract_f32 v54, v54
    v_fract_f32 v55, v55
    s_waitcnt vmcnt(36)
    v_mfma_f32_32x32x16_bf16 a[0:15], v[80:83], v[88:91], a[0:15]
    v_mfma_f32_32x32x16_bf16 a[16:31], v[80:83], v[92:95], a[16:31]
    v_mfma_f32_32x32x16_bf16 a[32:47], v[84:87], v[88:91], a[32:47]
    v_mfma_f32_32x32x16_bf16 a[48:63], v[84:87], v[92:95], a[48:63]
    buffer_load_dwordx4 v[80:83], v3, s[8:11], s44 offen offset:0
    buffer_load_dwordx4 v[84:87], v3, s[8:11], s45 offen offset:0
    buffer_load_dwordx4 v[88:91], v3, s[8:11], s46 offen offset:0
    buffer_load_dwordx4 v[92:95], v3, s[8:11], s47 offen offset:0
    s_waitcnt vmcnt(36)
    v_mfma_f32_32x32x16_bf16 a[0:15], v[96:99], v[104:107], a[0:15]
    v_mfma_f32_32x32x16_bf16 a[16:31], v[96:99], v[108:111], a[16:31]
    v_mfma_f32_32x32x16_bf16 a[32:47], v[100:103], v[104:107], a[32:47]
    v_mfma_f32_32x32x16_bf16 a[48:63], v[100:103], v[108:111], a[48:63]
    buffer_load_dwordx4 v[96:99], v3, s[8:11], s49 offen offset:1024
    buffer_load_dwordx4 v[100:103], v3, s[8:11], s51 offen offset:1024
    s_waitcnt vmcnt(36)
    v_mfma_f32_32x32x16_bf16 a[64:79], v[56:59], v[112:115], a[64:79]
    v_mfma_f32_32x32x16_bf16 a[80:95], v[60:63], v[116:119], a[80:95]
    v_mfma_f32_32x32x16_bf16 a[96:111], v[12:15], v[112:115], a[96:111]
    buffer_load_dwordx4 v[112:115], v3, s[8:11], s44 offen offset:1024
    buffer_load_dwordx4 v[116:119], v3, s[8:11], s45 offen offset:1024
    buffer_load_dwordx4 v[120:123], v3, s[8:11], s46 offen offset:1024
    buffer_load_dwordx4 v[124:127], v3, s[8:11], s47 offen offset:1024
    v_cos_f32 v2, v48
    v_cos_f32 v6, v49
    v_cos_f32 v7, v50
    v_cos_f32 v8, v51
    v_sin_f32_e64 v10, -v48
    v_cvt_pk_bf16_f32 v56, v2, v6
    v_cvt_pk_bf16_f32 v57, v7, v8
    v_sin_f32_e64 v6, -v49
    v_sin_f32_e64 v7, -v50
    v_sin_f32_e64 v8, -v51
    v_add_f32 v48, v11, v48
    v_cvt_pk_bf16_f32 v60, v10, v6
    v_cvt_pk_bf16_f32 v61, v7, v8
    v_add_f32 v49, v11, v49
    v_add_f32 v50, v11, v50
    v_add_f32 v51, v11, v51
    v_fract_f32 v48, v48
    v_fract_f32 v49, v49
    v_fract_f32 v50, v50
    v_fract_f32 v51, v51
    v_cos_f32 v2, v52
    v_cos_f32 v6, v53
    v_cos_f32 v7, v54
    v_cos_f32 v8, v55
    v_sin_f32_e64 v10, -v52
    v_cvt_pk_bf16_f32 v58, v2, v6
    v_cvt_pk_bf16_f32 v59, v7, v8
    v_sin_f32_e64 v6, -v53
    v_sin_f32_e64 v7, -v54
    v_sin_f32_e64 v8, -v55
    v_add_f32 v52, v11, v52
    v_cvt_pk_bf16_f32 v62, v10, v6
    v_cvt_pk_bf16_f32 v63, v7, v8
    v_add_f32 v53, v11, v53
    v_add_f32 v54, v11, v54
    v_add_f32 v55, v11, v55
    v_fract_f32 v52, v52
    v_fract_f32 v53, v53
    v_fract_f32 v54, v54
    v_fract_f32 v55, v55
    s_waitcnt vmcnt(36)
    v_mfma_f32_32x32x16_bf16 a[0:15], v[128:131], v[136:139], a[0:15]
    v_mfma_f32_32x32x16_bf16 a[16:31], v[128:131], v[140:143], a[16:31]
    v_mfma_f32_32x32x16_bf16 a[32:47], v[132:135], v[136:139], a[32:47]
    v_mfma_f32_32x32x16_bf16 a[48:63], v[132:135], v[140:143], a[48:63]
    buffer_load_dwordx4 v[128:131], v3, s[8:11], s44 offen offset:2048
    buffer_load_dwordx4 v[132:135], v3, s[8:11], s45 offen offset:2048
    buffer_load_dwordx4 v[136:139], v3, s[8:11], s46 offen offset:2048
    buffer_load_dwordx4 v[140:143], v3, s[8:11], s47 offen offset:2048
    s_waitcnt vmcnt(36)
    v_mfma_f32_32x32x16_bf16 a[0:15], v[144:147], v[152:155], a[0:15]
    v_mfma_f32_32x32x16_bf16 a[16:31], v[144:147], v[156:159], a[16:31]
    v_mfma_f32_32x32x16_bf16 a[32:47], v[148:151], v[152:155], a[32:47]
    v_mfma_f32_32x32x16_bf16 a[48:63], v[148:151], v[156:159], a[48:63]
    buffer_load_dwordx4 v[144:147], v3, s[8:11], s49 offen offset:2048
    buffer_load_dwordx4 v[148:151], v3, s[8:11], s51 offen offset:2048
    s_waitcnt vmcnt(36)
    v_mfma_f32_32x32x16_bf16 a[64:79], v[56:59], v[160:163], a[64:79]
    v_mfma_f32_32x32x16_bf16 a[80:95], v[60:63], v[164:167], a[80:95]
    v_mfma_f32_32x32x16_bf16 a[96:111], v[12:15], v[160:163], a[96:111]
    buffer_load_dwordx4 v[160:163], v3, s[8:11], s44 offen offset:3072
    buffer_load_dwordx4 v[164:167], v3, s[8:11], s45 offen offset:3072
    buffer_load_dwordx4 v[168:171], v3, s[8:11], s46 offen offset:3072
    buffer_load_dwordx4 v[172:175], v3, s[8:11], s47 offen offset:3072
    s_cmp_eq_u32 s52, 2
    s_cselect_b32 s55, -24576, s54
    s_add_u32 s44, s44, s55
    s_add_u32 s45, s45, s55
    s_add_u32 s46, s46, s55
    s_add_u32 s47, s47, s55
    v_cos_f32 v2, v48
    v_cos_f32 v6, v49
    v_cos_f32 v7, v50
    v_cos_f32 v8, v51
    v_sin_f32_e64 v10, -v48
    v_cvt_pk_bf16_f32 v56, v2, v6
    v_cvt_pk_bf16_f32 v57, v7, v8
    v_sin_f32_e64 v6, -v49
    v_sin_f32_e64 v7, -v50
    v_sin_f32_e64 v8, -v51
    v_add_f32 v48, v11, v48
    v_cvt_pk_bf16_f32 v60, v10, v6
    v_cvt_pk_bf16_f32 v61, v7, v8
    v_add_f32 v49, v11, v49
    v_add_f32 v50, v11, v50
    v_add_f32 v51, v11, v51
    v_fract_f32 v48, v48
    v_fract_f32 v49, v49
    v_fract_f32 v50, v50
    v_fract_f32 v51, v51
    v_cos_f32 v2, v52
    v_cos_f32 v6, v53
    v_cos_f32 v7, v54
    v_cos_f32 v8, v55
    v_sin_f32_e64 v10, -v52
    v_cvt_pk_bf16_f32 v58, v2, v6
    v_cvt_pk_bf16_f32 v59, v7, v8
    v_sin_f32_e64 v6, -v53
    v_sin_f32_e64 v7, -v54
    v_sin_f32_e64 v8, -v55
    v_add_f32 v52, v11, v52
    v_cvt_pk_bf16_f32 v62, v10, v6
    v_cvt_pk_bf16_f32 v63, v7, v8
    v_add_f32 v53, v11, v53
    v_add_f32 v54, v11, v54
    v_add_f32 v55, v11, v55
    v_fract_f32 v52, v52
    v_fract_f32 v53, v53
    v_fract_f32 v54, v54
    v_fract_f32 v55, v55
    s_waitcnt vmcnt(36)
    v_mfma_f32_32x32x16_bf16 a[0:15], v[176:179], v[184:187], a[0:15]
    v_mfma_f32_32x32x16_bf16 a[16:31], v[176:179], v[188:191], a[16:31]
    v_mfma_f32_32x32x16_bf16 a[32:47], v[180:183], v[184:187], a[32:47]
    v_mfma_f32_32x32x16_bf16 a[48:63], v[180:183], v[188:191], a[48:63]
    buffer_load_dwordx4 v[176:179], v3, s[8:11], s49 offen offset:3072
    buffer_load_dwordx4 v[180:183], v3, s[8:11], s51 offen offset:3072
    s_add_u32 s49, s49, 4096
    s_add_u32 s51, s51, 4096
    s_waitcnt vmcnt(36)
    v_mfma_f32_32x32x16_bf16 a[64:79], v[56:59], v[192:195], a[64:79]
    v_mfma_f32_32x32x16_bf16 a[80:95], v[60:63], v[196:199], a[80:95]
    v_mfma_f32_32x32x16_bf16 a[96:111], v[12:15], v[192:195], a[96:111]
    buffer_load_dwordx4 v[192:195], v3, s[8:11], s44 offen offset:0
    buffer_load_dwordx4 v[196:199], v3, s[8:11], s45 offen offset:0
    buffer_load_dwordx4 v[200:203], v3, s[8:11], s46 offen offset:0
    buffer_load_dwordx4 v[204:207], v3, s[8:11], s47 offen offset:0
    v_cos_f32 v2, v48
    v_cos_f32 v6, v49
    v_cos_f32 v7, v50
    v_cos_f32 v8, v51
    v_sin_f32_e64 v10, -v48
    v_cvt_pk_bf16_f32 v56, v2, v6
    v_cvt_pk_bf16_f32 v57, v7, v8
    v_sin_f32_e64 v6, -v49
    v_sin_f32_e64 v7, -v50
    v_sin_f32_e64 v8, -v51
    v_add_f32 v48, v11, v48
    v_cvt_pk_bf16_f32 v60, v10, v6
    v_cvt_pk_bf16_f32 v61, v7, v8
    v_add_f32 v49, v11, v49
    v_add_f32 v50, v11, v50
    v_add_f32 v51, v11, v51
    v_fract_f32 v48, v48
    v_fract_f32 v49, v49
    v_fract_f32 v50, v50
    v_fract_f32 v51, v51
    v_cos_f32 v2, v52
    v_cos_f32 v6, v53
    v_cos_f32 v7, v54
    v_cos_f32 v8, v55
    v_sin_f32_e64 v10, -v52
    v_cvt_pk_bf16_f32 v58, v2, v6
    v_cvt_pk_bf16_f32 v59, v7, v8
    v_sin_f32_e64 v6, -v53
    v_sin_f32_e64 v7, -v54
    v_sin_f32_e64 v8, -v55
    v_add_f32 v52, v11, v52
    v_cvt_pk_bf16_f32 v62, v10, v6
    v_cvt_pk_bf16_f32 v63, v7, v8
    v_add_f32 v53, v11, v53
    v_add_f32 v54, v11, v54
    v_add_f32 v55, v11, v55
    v_fract_f32 v52, v52
    v_fract_f32 v53, v53
    v_fract_f32 v54, v54
    v_fract_f32 v55, v55
    s_waitcnt vmcnt(36)
    v_mfma_f32_32x32x16_bf16 a[0:15], v[208:211], v[216:219], a[0:15]
    v_mfma_f32_32x32x16_bf16 a[16:31], v[208:211], v[220:223], a[16:31]
    v_mfma_f32_32x32x16_bf16 a[32:47], v[212:215], v[216:219], a[32:47]
    v_mfma_f32_32x32x16_bf16 a[48:63], v[212:215], v[220:223], a[48:63]
    buffer_load_dwordx4 v[208:211], v3, s[8:11], s44 offen offset:1024
    buffer_load_dwordx4 v[212:215], v3, s[8:11], s45 offen offset:1024
    buffer_load_dwordx4 v[216:219], v3, s[8:11], s46 offen offset:1024
    buffer_load_dwordx4 v[220:223], v3, s[8:11], s47 offen offset:1024
    s_waitcnt vmcnt(36)
    v_mfma_f32_32x32x16_bf16 a[0:15], v[224:227], v[232:235], a[0:15]
    v_mfma_f32_32x32x16_bf16 a[16:31], v[224:227], v[236:239], a[16:31]
    v_mfma_f32_32x32x16_bf16 a[32:47], v[228:231], v[232:235], a[32:47]
    v_mfma_f32_32x32x16_bf16 a[48:63], v[228:231], v[236:239], a[48:63]
    buffer_load_dwordx4 v[224:227], v3, s[8:11], s49 offen offset:0
    buffer_load_dwordx4 v[228:231], v3, s[8:11], s51 offen offset:0
    s_waitcnt vmcnt(36)
    v_mfma_f32_32x32x16_bf16 a[64:79], v[56:59], v[240:243], a[64:79]
    v_mfma_f32_32x32x16_bf16 a[80:95], v[60:63], v[244:247], a[80:95]
    v_mfma_f32_32x32x16_bf16 a[96:111], v[12:15], v[240:243], a[96:111]
    buffer_load_dwordx4 v[240:243], v3, s[8:11], s44 offen offset:2048
    buffer_load_dwordx4 v[244:247], v3, s[8:11], s45 offen offset:2048
    buffer_load_dwordx4 v[248:251], v3, s[8:11], s46 offen offset:2048
    buffer_load_dwordx4 v[252:255], v3, s[8:11], s47 offen offset:2048
    v_cos_f32 v2, v48
    v_cos_f32 v6, v49
    v_cos_f32 v7, v50
    v_cos_f32 v8, v51
    v_sin_f32_e64 v10, -v48
    v_cvt_pk_bf16_f32 v56, v2, v6
    v_cvt_pk_bf16_f32 v57, v7, v8
    v_sin_f32_e64 v6, -v49
    v_sin_f32_e64 v7, -v50
    v_sin_f32_e64 v8, -v51
    v_add_f32 v48, v11, v48
    v_cvt_pk_bf16_f32 v60, v10, v6
    v_cvt_pk_bf16_f32 v61, v7, v8
    v_add_f32 v49, v11, v49
    v_add_f32 v50, v11, v50
    v_add_f32 v51, v11, v51
    v_fract_f32 v48, v48
    v_fract_f32 v49, v49
    v_fract_f32 v50, v50
    v_fract_f32 v51, v51
    v_cos_f32 v2, v52
    v_cos_f32 v6, v53
    v_cos_f32 v7, v54
    v_cos_f32 v8, v55
    v_sin_f32_e64 v10, -v52
    v_cvt_pk_bf16_f32 v58, v2, v6
    v_cvt_pk_bf16_f32 v59, v7, v8
    v_sin_f32_e64 v6, -v53
    v_sin_f32_e64 v7, -v54
    v_sin_f32_e64 v8, -v55
    v_add_f32 v52, v11, v52
    v_cvt_pk_bf16_f32 v62, v10, v6
    v_cvt_pk_bf16_f32 v63, v7, v8
    v_add_f32 v53, v11, v53
    v_add_f32 v54, v11, v54
    v_add_f32 v55, v11, v55
    v_fract_f32 v52, v52
    v_fract_f32 v53, v53
    v_fract_f32 v54, v54
    v_fract_f32 v55, v55
    s_waitcnt vmcnt(36)
    v_mfma_f32_32x32x16_bf16 a[0:15], v[64:67], v[72:75], a[0:15]
    v_mfma_f32_32x32x16_bf16 a[16:31], v[64:67], v[76:79], a[16:31]
    v_mfma_f32_32x32x16_bf16 a[32:47], v[68:71], v[72:75], a[32:47]
    v_mfma_f32_32x32x16_bf16 a[48:63], v[68:71], v[76:79], a[48:63]
    buffer_load_dwordx4 v[64:67], v3, s[8:11], s44 offen offset:3072
    buffer_load_dwordx4 v[68:71], v3, s[8:11], s45 offen offset:3072
    buffer_load_dwordx4 v[72:75], v3, s[8:11], s46 offen offset:3072
    buffer_load_dwordx4 v[76:79], v3, s[8:11], s47 offen offset:3072
    s_cmp_eq_u32 s52, 1
    s_cselect_b32 s55, -24576, s54
    s_add_u32 s44, s44, s55
    s_add_u32 s45, s45, s55
    s_add_u32 s46, s46, s55
    s_add_u32 s47, s47, s55
    s_waitcnt vmcnt(36)
    v_mfma_f32_32x32x16_bf16 a[0:15], v[80:83], v[88:91], a[0:15]
    v_mfma_f32_32x32x16_bf16 a[16:31], v[80:83], v[92:95], a[16:31]
    v_mfma_f32_32x32x16_bf16 a[32:47], v[84:87], v[88:91], a[32:47]
    v_mfma_f32_32x32x16_bf16 a[48:63], v[84:87], v[92:95], a[48:63]
    buffer_load_dwordx4 v[80:83], v3, s[8:11], s49 offen offset:1024
    buffer_load_dwordx4 v[84:87], v3, s[8:11], s51 offen offset:1024
    s_waitcnt vmcnt(36)
    v_mfma_f32_32x32x16_bf16 a[64:79], v[56:59], v[96:99], a[64:79]
    v_mfma_f32_32x32x16_bf16 a[80:95], v[60:63], v[100:103], a[80:95]
    v_mfma_f32_32x32x16_bf16 a[96:111], v[12:15], v[96:99], a[96:111]
    buffer_load_dwordx4 v[96:99], v3, s[8:11], s44 offen offset:0
    buffer_load_dwordx4 v[100:103], v3, s[8:11], s45 offen offset:0
    buffer_load_dwordx4 v[104:107], v3, s[8:11], s46 offen offset:0
    buffer_load_dwordx4 v[108:111], v3, s[8:11], s47 offen offset:0
    v_cos_f32 v2, v48
    v_cos_f32 v6, v49
    v_cos_f32 v7, v50
    v_cos_f32 v8, v51
    v_sin_f32_e64 v10, -v48
    v_cvt_pk_bf16_f32 v56, v2, v6
    v_cvt_pk_bf16_f32 v57, v7, v8
    v_sin_f32_e64 v6, -v49
    v_sin_f32_e64 v7, -v50
    v_sin_f32_e64 v8, -v51
    v_add_f32 v48, v11, v48
    v_cvt_pk_bf16_f32 v60, v10, v6
    v_cvt_pk_bf16_f32 v61, v7, v8
    v_add_f32 v49, v11, v49
    v_add_f32 v50, v11, v50
    v_add_f32 v51, v11, v51
    v_fract_f32 v48, v48
    v_fract_f32 v49, v49
    v_fract_f32 v50, v50
    v_fract_f32 v51, v51
    v_cos_f32 v2, v52
    v_cos_f32 v6, v53
    v_cos_f32 v7, v54
    v_cos_f32 v8, v55
    v_sin_f32_e64 v10, -v52
    v_cvt_pk_bf16_f32 v58, v2, v6
    v_cvt_pk_bf16_f32 v59, v7, v8
    v_sin_f32_e64 v6, -v53
    v_sin_f32_e64 v7, -v54
    v_sin_f32_e64 v8, -v55
    v_add_f32 v52, v11, v52
    v_cvt_pk_bf16_f32 v62, v10, v6
    v_cvt_pk_bf16_f32 v63, v7, v8
    v_add_f32 v53, v11, v53
    v_add_f32 v54, v11, v54
    v_add_f32 v55, v11, v55
    v_fract_f32 v52, v52
    v_fract_f32 v53, v53
    v_fract_f32 v54, v54
    v_fract_f32 v55, v55
    s_waitcnt vmcnt(36)
    v_mfma_f32_32x32x16_bf16 a[0:15], v[112:115], v[120:123], a[0:15]
    v_mfma_f32_32x32x16_bf16 a[16:31], v[112:115], v[124:127], a[16:31]
    v_mfma_f32_32x32x16_bf16 a[32:47], v[116:119], v[120:123], a[32:47]
    v_mfma_f32_32x32x16_bf16 a[48:63], v[116:119], v[124:127], a[48:63]
    buffer_load_dwordx4 v[112:115], v3, s[8:11], s44 offen offset:1024
    buffer_load_dwordx4 v[116:119], v3, s[8:11], s45 offen offset:1024
    buffer_load_dwordx4 v[120:123], v3, s[8:11], s46 offen offset:1024
    buffer_load_dwordx4 v[124:127], v3, s[8:11], s47 offen offset:1024
    s_waitcnt vmcnt(36)
    v_mfma_f32_32x32x16_bf16 a[0:15], v[128:131], v[136:139], a[0:15]
    v_mfma_f32_32x32x16_bf16 a[16:31], v[128:131], v[140:143], a[16:31]
    v_mfma_f32_32x32x16_bf16 a[32:47], v[132:135], v[136:139], a[32:47]
    v_mfma_f32_32x32x16_bf16 a[48:63], v[132:135], v[140:143], a[48:63]
    buffer_load_dwordx4 v[128:131], v3, s[8:11], s49 offen offset:2048
    buffer_load_dwordx4 v[132:135], v3, s[8:11], s51 offen offset:2048
    s_waitcnt vmcnt(36)
    v_mfma_f32_32x32x16_bf16 a[64:79], v[56:59], v[144:147], a[64:79]
    v_mfma_f32_32x32x16_bf16 a[80:95], v[60:63], v[148:151], a[80:95]
    v_mfma_f32_32x32x16_bf16 a[96:111], v[12:15], v[144:147], a[96:111]
    buffer_load_dwordx4 v[144:147], v3, s[8:11], s44 offen offset:2048
    buffer_load_dwordx4 v[148:151], v3, s[8:11], s45 offen offset:2048
    buffer_load_dwordx4 v[152:155], v3, s[8:11], s46 offen offset:2048
    buffer_load_dwordx4 v[156:159], v3, s[8:11], s47 offen offset:2048
    v_cos_f32 v2, v48
    v_cos_f32 v6, v49
    v_cos_f32 v7, v50
    v_cos_f32 v8, v51
    v_sin_f32_e64 v10, -v48
    v_cvt_pk_bf16_f32 v56, v2, v6
    v_cvt_pk_bf16_f32 v57, v7, v8
    v_sin_f32_e64 v6, -v49
    v_sin_f32_e64 v7, -v50
    v_sin_f32_e64 v8, -v51
    v_add_f32 v48, v11, v48
    v_cvt_pk_bf16_f32 v60, v10, v6
    v_cvt_pk_bf16_f32 v61, v7, v8
    v_add_f32 v49, v11, v49
    v_add_f32 v50, v11, v50
    v_add_f32 v51, v11, v51
    v_fract_f32 v48, v48
    v_fract_f32 v49, v49
    v_fract_f32 v50, v50
    v_fract_f32 v51, v51
    v_cos_f32 v2, v52
    v_cos_f32 v6, v53
    v_cos_f32 v7, v54
    v_cos_f32 v8, v55
    v_sin_f32_e64 v10, -v52
    v_cvt_pk_bf16_f32 v58, v2, v6
    v_cvt_pk_bf16_f32 v59, v7, v8
    v_sin_f32_e64 v6, -v53
    v_sin_f32_e64 v7, -v54
    v_sin_f32_e64 v8, -v55
    v_add_f32 v52, v11, v52
    v_cvt_pk_bf16_f32 v62, v10, v6
    v_cvt_pk_bf16_f32 v63, v7, v8
    v_add_f32 v53, v11, v53
    v_add_f32 v54, v11, v54
    v_add_f32 v55, v11, v55
    v_fract_f32 v52, v52
    v_fract_f32 v53, v53
    v_fract_f32 v54, v54
    v_fract_f32 v55, v55
    s_waitcnt vmcnt(36)
    v_mfma_f32_32x32x16_bf16 a[0:15], v[160:163], v[168:171], a[0:15]
    v_mfma_f32_32x32x16_bf16 a[16:31], v[160:163], v[172:175], a[16:31]
    v_mfma_f32_32x32x16_bf16 a[32:47], v[164:167], v[168:171], a[32:47]
    v_mfma_f32_32x32x16_bf16 a[48:63], v[164:167], v[172:175], a[48:63]
    buffer_load_dwordx4 v[160:163], v3, s[8:11], s49 offen offset:3072
    buffer_load_dwordx4 v[164:167], v3, s[8:11], s51 offen offset:3072
    s_add_u32 s49, s49, 4096
    s_add_u32 s51, s51, 4096
    s_waitcnt vmcnt(36)
    v_mfma_f32_32x32x16_bf16 a[64:79], v[56:59], v[176:179], a[64:79]
    v_mfma_f32_32x32x16_bf16 a[80:95], v[60:63], v[180:183], a[80:95]
    v_mfma_f32_32x32x16_bf16 a[96:111], v[12:15], v[176:179], a[96:111]
    buffer_load_dwordx4 v[176:179], v3, s[8:11], s44 offen offset:3072
    buffer_load_dwordx4 v[180:183], v3, s[8:11], s45 offen offset:3072
    buffer_load_dwordx4 v[184:187], v3, s[8:11], s46 offen offset:3072
    buffer_load_dwordx4 v[188:191], v3, s[8:11], s47 offen offset:3072
    s_cmp_eq_u32 s52, 0
    s_cselect_b32 s55, -24576, s54
    s_add_u32 s44, s44, s55
    s_add_u32 s45, s45, s55
    s_add_u32 s46, s46, s55
    s_add_u32 s47, s47, s55
    v_cos_f32 v2, v48
    v_cos_f32 v6, v49
    v_cos_f32 v7, v50
    v_cos_f32 v8, v51
    v_sin_f32_e64 v10, -v48
    v_cvt_pk_bf16_f32 v56, v2, v6
    v_cvt_pk_bf16_f32 v57, v7, v8
    v_sin_f32_e64 v6, -v49
    v_sin_f32_e64 v7, -v50
    v_sin_f32_e64 v8, -v51
    v_add_f32 v48, v11, v48
    v_cvt_pk_bf16_f32 v60, v10, v6
    v_cvt_pk_bf16_f32 v61, v7, v8
    v_add_f32 v49, v11, v49
    v_add_f32 v50, v11, v50
    v_add_f32 v51, v11, v51
    v_fract_f32 v48, v48
    v_fract_f32 v49, v49
    v_fract_f32 v50, v50
    v_fract_f32 v51, v51
    v_cos_f32 v2, v52
    v_cos_f32 v6, v53
    v_cos_f32 v7, v54
    v_cos_f32 v8, v55
    v_sin_f32_e64 v10, -v52
    v_cvt_pk_bf16_f32 v58, v2, v6
    v_cvt_pk_bf16_f32 v59, v7, v8
    v_sin_f32_e64 v6, -v53
    v_sin_f32_e64 v7, -v54
    v_sin_f32_e64 v8, -v55
    v_add_f32 v52, v11, v52
    v_cvt_pk_bf16_f32 v62, v10, v6
    v_cvt_pk_bf16_f32 v63, v7, v8
    v_add_f32 v53, v11, v53
    v_add_f32 v54, v11, v54
    v_add_f32 v55, v11, v55
    v_fract_f32 v52, v52
    v_fract_f32 v53, v53
    v_fract_f32 v54, v54
    v_fract_f32 v55, v55
    s_waitcnt vmcnt(36)
    v_mfma_f32_32x32x16_bf16 a[0:15], v[192:195], v[200:203], a[0:15]
    v_mfma_f32_32x32x16_bf16 a[16:31], v[192:195], v[204:207], a[16:31]
    v_mfma_f32_32x32x16_bf16 a[32:47], v[196:199], v[200:203], a[32:47]
    v_mfma_f32_32x32x16_bf16 a[48:63], v[196:199], v[204:207], a[48:63]
    s_waitcnt vmcnt(32)
    v_mfma_f32_32x32x16_bf16 a[0:15], v[208:211], v[216:219], a[0:15]
    v_mfma_f32_32x32x16_bf16 a[16:31], v[208:211], v[220:223], a[16:31]
    v_mfma_f32_32x32x16_bf16 a[32:47], v[212:215], v[216:219], a[32:47]
    v_mfma_f32_32x32x16_bf16 a[48:63], v[212:215], v[220:223], a[48:63]
    s_waitcnt vmcnt(30)
    v_mfma_f32_32x32x16_bf16 a[64:79], v[56:59], v[224:227], a[64:79]
    v_mfma_f32_32x32x16_bf16 a[80:95], v[60:63], v[228:231], a[80:95]
    v_mfma_f32_32x32x16_bf16 a[96:111], v[12:15], v[224:227], a[96:111]
    v_cos_f32 v2, v48
    v_cos_f32 v6, v49
    v_cos_f32 v7, v50
    v_cos_f32 v8, v51
    v_sin_f32_e64 v10, -v48
    v_cvt_pk_bf16_f32 v56, v2, v6
    v_cvt_pk_bf16_f32 v57, v7, v8
    v_sin_f32_e64 v6, -v49
    v_sin_f32_e64 v7, -v50
    v_sin_f32_e64 v8, -v51
    v_add_f32 v48, v11, v48
    v_cvt_pk_bf16_f32 v60, v10, v6
    v_cvt_pk_bf16_f32 v61, v7, v8
    v_add_f32 v49, v11, v49
    v_add_f32 v50, v11, v50
    v_add_f32 v51, v11, v51
    v_fract_f32 v48, v48
    v_fract_f32 v49, v49
    v_fract_f32 v50, v50
    v_fract_f32 v51, v51
    v_cos_f32 v2, v52
    v_cos_f32 v6, v53
    v_cos_f32 v7, v54
    v_cos_f32 v8, v55
    v_sin_f32_e64 v10, -v52
    v_cvt_pk_bf16_f32 v58, v2, v6
    v_cvt_pk_bf16_f32 v59, v7, v8
    v_sin_f32_e64 v6, -v53
    v_sin_f32_e64 v7, -v54
    v_sin_f32_e64 v8, -v55
    v_add_f32 v52, v11, v52
    v_cvt_pk_bf16_f32 v62, v10, v6
    v_cvt_pk_bf16_f32 v63, v7, v8
    v_add_f32 v53, v11, v53
    v_add_f32 v54, v11, v54
    v_add_f32 v55, v11, v55
    v_fract_f32 v52, v52
    v_fract_f32 v53, v53
    v_fract_f32 v54, v54
    v_fract_f32 v55, v55
    s_waitcnt vmcnt(26)
    v_mfma_f32_32x32x16_bf16 a[0:15], v[240:243], v[248:251], a[0:15]
    v_mfma_f32_32x32x16_bf16 a[16:31], v[240:243], v[252:255], a[16:31]
    v_mfma_f32_32x32x16_bf16 a[32:47], v[244:247], v[248:251], a[32:47]
    v_mfma_f32_32x32x16_bf16 a[48:63], v[244:247], v[252:255], a[48:63]
    s_waitcnt vmcnt(22)
    v_mfma_f32_32x32x16_bf16 a[0:15], v[64:67], v[72:75], a[0:15]
    v_mfma_f32_32x32x16_bf16 a[16:31], v[64:67], v[76:79], a[16:31]
    v_mfma_f32_32x32x16_bf16 a[32:47], v[68:71], v[72:75], a[32:47]
    v_mfma_f32_32x32x16_bf16 a[48:63], v[68:71], v[76:79], a[48:63]
    s_waitcnt vmcnt(20)
    v_mfma_f32_32x32x16_bf16 a[64:79], v[56:59], v[80:83], a[64:79]
    v_mfma_f32_32x32x16_bf16 a[80:95], v[60:63], v[84:87], a[80:95]
    v_mfma_f32_32x32x16_bf16 a[96:111], v[12:15], v[80:83], a[96:111]
    v_cos_f32 v2, v48
    v_cos_f32 v6, v49
    v_cos_f32 v7, v50
    v_cos_f32 v8, v51
    v_sin_f32_e64 v10, -v48
    v_cvt_pk_bf16_f32 v56, v2, v6
    v_cvt_pk_bf16_f32 v57, v7, v8
    v_sin_f32_e64 v6, -v49
    v_sin_f32_e64 v7, -v50
    v_sin_f32_e64 v8, -v51
    v_add_f32 v48, v11, v48
    v_cvt_pk_bf16_f32 v60, v10, v6
    v_cvt_pk_bf16_f32 v61, v7, v8
    v_add_f32 v49, v11, v49
    v_add_f32 v50, v11, v50
    v_add_f32 v51, v11, v51
    v_fract_f32 v48, v48
    v_fract_f32 v49, v49
    v_fract_f32 v50, v50
    v_fract_f32 v51, v51
    v_cos_f32 v2, v52
    v_cos_f32 v6, v53
    v_cos_f32 v7, v54
    v_cos_f32 v8, v55
    v_sin_f32_e64 v10, -v52
    v_cvt_pk_bf16_f32 v58, v2, v6
    v_cvt_pk_bf16_f32 v59, v7, v8
    v_sin_f32_e64 v6, -v53
    v_sin_f32_e64 v7, -v54
    v_sin_f32_e64 v8, -v55
    v_add_f32 v52, v11, v52
    v_cvt_pk_bf16_f32 v62, v10, v6
    v_cvt_pk_bf16_f32 v63, v7, v8
    v_add_f32 v53, v11, v53
    v_add_f32 v54, v11, v54
    v_add_f32 v55, v11, v55
    v_fract_f32 v52, v52
    v_fract_f32 v53, v53
    v_fract_f32 v54, v54
    v_fract_f32 v55, v55
    s_waitcnt vmcnt(16)
    v_mfma_f32_32x32x16_bf16 a[0:15], v[96:99], v[104:107], a[0:15]
    v_mfma_f32_32x32x16_bf16 a[16:31], v[96:99], v[108:111], a[16:31]
    v_mfma_f32_32x32x16_bf16 a[32:47], v[100:103], v[104:107], a[32:47]
    v_mfma_f32_32x32x16_bf16 a[48:63], v[100:103], v[108:111], a[48:63]
    s_waitcnt vmcnt(12)
    v_mfma_f32_32x32x16_bf16 a[0:15], v[112:115], v[120:123], a[0:15]
    v_mfma_f32_32x32x16_bf16 a[16:31], v[112:115], v[124:127], a[16:31]
    v_mfma_f32_32x32x16_bf16 a[32:47], v[116:119], v[120:123], a[32:47]
    v_mfma_f32_32x32x16_bf16 a[48:63], v[116:119], v[124:127], a[48:63]
    s_waitcnt vmcnt(10)
    v_mfma_f32_32x32x16_bf16 a[64:79], v[56:59], v[128:131], a[64:79]
    v_mfma_f32_32x32x16_bf16 a[80:95], v[60:63], v[132:135], a[80:95]
    v_mfma_f32_32x32x16_bf16 a[96:111], v[12:15], v[128:131], a[96:111]
    v_cos_f32 v2, v48
    v_cos_f32 v6, v49
    v_cos_f32 v7, v50
    v_cos_f32 v8, v51
    v_sin_f32_e64 v10, -v48
    v_cvt_pk_bf16_f32 v56, v2, v6
    v_cvt_pk_bf16_f32 v57, v7, v8
    v_sin_f32_e64 v6, -v49
    v_sin_f32_e64 v7, -v50
    v_sin_f32_e64 v8, -v51
    v_add_f32 v48, v11, v48
    v_cvt_pk_bf16_f32 v60, v10, v6
    v_cvt_pk_bf16_f32 v61, v7, v8
    v_add_f32 v49, v11, v49
    v_add_f32 v50, v11, v50
    v_add_f32 v51, v11, v51
    v_fract_f32 v48, v48
    v_fract_f32 v49, v49
    v_fract_f32 v50, v50
    v_fract_f32 v51, v51
    v_cos_f32 v2, v52
    v_cos_f32 v6, v53
    v_cos_f32 v7, v54
    v_cos_f32 v8, v55
    v_sin_f32_e64 v10, -v52
    v_cvt_pk_bf16_f32 v58, v2, v6
    v_cvt_pk_bf16_f32 v59, v7, v8
    v_sin_f32_e64 v6, -v53
    v_sin_f32_e64 v7, -v54
    v_sin_f32_e64 v8, -v55
    v_add_f32 v52, v11, v52
    v_cvt_pk_bf16_f32 v62, v10, v6
    v_cvt_pk_bf16_f32 v63, v7, v8
    v_add_f32 v53, v11, v53
    v_add_f32 v54, v11, v54
    v_add_f32 v55, v11, v55
    v_fract_f32 v52, v52
    v_fract_f32 v53, v53
    v_fract_f32 v54, v54
    v_fract_f32 v55, v55
    s_waitcnt vmcnt(6)
    v_mfma_f32_32x32x16_bf16 a[0:15], v[144:147], v[152:155], a[0:15]
    v_mfma_f32_32x32x16_bf16 a[16:31], v[144:147], v[156:159], a[16:31]
    v_mfma_f32_32x32x16_bf16 a[32:47], v[148:151], v[152:155], a[32:47]
    v_mfma_f32_32x32x16_bf16 a[48:63], v[148:151], v[156:159], a[48:63]
    s_waitcnt vmcnt(4)
    v_mfma_f32_32x32x16_bf16 a[64:79], v[56:59], v[160:163], a[64:79]
    v_mfma_f32_32x32x16_bf16 a[80:95], v[60:63], v[164:167], a[80:95]
    v_mfma_f32_32x32x16_bf16 a[96:111], v[12:15], v[160:163], a[96:111]
    s_waitcnt vmcnt(0)
    v_mfma_f32_32x32x16_bf16 a[0:15], v[176:179], v[184:187], a[0:15]
    v_mfma_f32_32x32x16_bf16 a[16:31], v[176:179], v[188:191], a[16:31]
    v_mfma_f32_32x32x16_bf16 a[32:47], v[180:183], v[184:187], a[32:47]
    v_mfma_f32_32x32x16_bf16 a[48:63], v[180:183], v[188:191], a[48:63]
    s_nop 7
    s_nop 7
    s_mul_i32 s26, s7, 24832
    v_add_u32 v10, s26, v3
    ds_write_b128 v10, a[0:3] offset:0
    v_accvgpr_read_b32 v64, a64
    v_accvgpr_read_b32 v65, a65
    v_accvgpr_read_b32 v96, a80
    ds_write_b128 v10, a[4:7] offset:1024
    v_accvgpr_read_b32 v97, a81
    v_pk_add_f32 v[80:81], v[64:65], v[96:97]
    v_pk_add_f32 v[64:65], v[64:65], v[96:97] neg_lo:[0,1] neg_hi:[0,1]
    ds_write_b128 v10, a[8:11] offset:2048
    v_accvgpr_read_b32 v66, a66
    v_accvgpr_read_b32 v67, a67
    v_accvgpr_read_b32 v98, a82
    ds_write_b128 v10, a[12:15] offset:3072
    v_accvgpr_read_b32 v99, a83
    v_pk_add_f32 v[82:83], v[66:67], v[98:99]
    v_pk_add_f32 v[66:67], v[66:67], v[98:99] neg_lo:[0,1] neg_hi:[0,1]
    ds_write_b128 v10, a[16:19] offset:4096
    v_accvgpr_read_b32 v68, a68
    v_accvgpr_read_b32 v69, a69
    v_accvgpr_read_b32 v100, a84
    ds_write_b128 v10, a[20:23] offset:5120
    v_accvgpr_read_b32 v101, a85
    v_pk_add_f32 v[84:85], v[68:69], v[100:101]
    v_pk_add_f32 v[68:69], v[68:69], v[100:101] neg_lo:[0,1] neg_hi:[0,1]
    ds_write_b128 v10, a[24:27] offset:6144
    v_accvgpr_read_b32 v70, a70
    v_accvgpr_read_b32 v71, a71
    v_accvgpr_read_b32 v102, a86
    ds_write_b128 v10, a[28:31] offset:7168
    v_accvgpr_read_b32 v103, a87
    v_pk_add_f32 v[86:87], v[70:71], v[102:103]
    v_pk_add_f32 v[70:71], v[70:71], v[102:103] neg_lo:[0,1] neg_hi:[0,1]
    ds_write_b128 v10, a[32:35] offset:8192
    v_accvgpr_read_b32 v72, a72
    v_accvgpr_read_b32 v73, a73
    v_accvgpr_read_b32 v104, a88
    ds_write_b128 v10, a[36:39] offset:9216
    v_accvgpr_read_b32 v105, a89
    v_pk_add_f32 v[88:89], v[72:73], v[104:105]
    v_pk_add_f32 v[72:73], v[72:73], v[104:105] neg_lo:[0,1] neg_hi:[0,1]
    ds_write_b128 v10, a[40:43] offset:10240
    v_accvgpr_read_b32 v74, a74
    v_accvgpr_read_b32 v75, a75
    v_accvgpr_read_b32 v106, a90
    ds_write_b128 v10, a[44:47] offset:11264
    v_accvgpr_read_b32 v107, a91
    v_pk_add_f32 v[90:91], v[74:75], v[106:107]
    v_pk_add_f32 v[74:75], v[74:75], v[106:107] neg_lo:[0,1] neg_hi:[0,1]
    ds_write_b128 v10, a[48:51] offset:12288
    v_accvgpr_read_b32 v76, a76
    v_accvgpr_read_b32 v77, a77
    v_accvgpr_read_b32 v108, a92
    ds_write_b128 v10, a[52:55] offset:13312
    v_accvgpr_read_b32 v109, a93
    v_pk_add_f32 v[92:93], v[76:77], v[108:109]
    v_pk_add_f32 v[76:77], v[76:77], v[108:109] neg_lo:[0,1] neg_hi:[0,1]
    ds_write_b128 v10, a[56:59] offset:14336
    v_accvgpr_read_b32 v78, a78
    v_accvgpr_read_b32 v79, a79
    v_accvgpr_read_b32 v110, a94
    ds_write_b128 v10, a[60:63] offset:15360
    v_accvgpr_read_b32 v111, a95
    v_pk_add_f32 v[94:95], v[78:79], v[110:111]
    v_pk_add_f32 v[78:79], v[78:79], v[110:111] neg_lo:[0,1] neg_hi:[0,1]
    ds_write_b128 v10, v[64:67] offset:16384
    ds_write_b128 v10, v[68:71] offset:17408
    ds_write_b128 v10, v[72:75] offset:18432
    ds_write_b128 v10, v[76:79] offset:19456
    ds_write_b128 v10, v[80:83] offset:20480
    ds_write_b128 v10, v[84:87] offset:21504
    ds_write_b128 v10, v[88:91] offset:22528
    ds_write_b128 v10, v[92:95] offset:23552
    v_lshlrev_b32 v11, 2, v1
    v_add_u32 v11, s26, v11
    v_accvgpr_read_b32 v8, a96
    ds_write_b32 v11, v8 offset:24576
    v_lshlrev_b32 v32, 16, v32
    v_lshlrev_b32 v33, 16, v33
    v_lshlrev_b32 v34, 16, v34
    v_lshlrev_b32 v35, 16, v35
    v_lshlrev_b32 v36, 16, v36
    v_lshlrev_b32 v37, 16, v37
    v_lshlrev_b32 v38, 16, v38
    v_lshlrev_b32 v39, 16, v39
    v_lshlrev_b32 v40, 16, v40
    v_lshlrev_b32 v41, 16, v41
    v_lshlrev_b32 v42, 16, v42
    v_lshlrev_b32 v43, 16, v43
    v_lshlrev_b32 v44, 16, v44
    v_lshlrev_b32 v45, 16, v45
    v_lshlrev_b32 v46, 16, v46
    v_lshlrev_b32 v47, 16, v47
    s_mov_b32 s60, 0xbfb8aa3b
    s_mov_b32 s61, s60
    s_mov_b32 s62, 1.0
    s_mov_b32 s63, 1.0
    v_mov_b32 v52, v9
    v_xor_b32 v53, 0x80000000, v9
    s_waitcnt lgkmcnt(0)
    s_barrier
    s_lshl_b32 s27, s7, 12
    v_add_u32 v10, s27, v3
    s_xor_b32 s27, s22, s23
    s_add_u32 s27, s27, 4
    s_lshl_b32 s27, s27, 12
    v_add_u32 v11, s27, v3
    v_add_u32 v6, 49664, v10
    v_add_u32 v7, 49664, v11
    ds_read_b128 v[64:67], v10 offset:0
    ds_read_b128 v[68:71], v10 offset:1024
    ds_read_b128 v[72:75], v10 offset:2048
    ds_read_b128 v[76:79], v10 offset:3072
    ds_read_b128 v[80:83], v10 offset:24832
    ds_read_b128 v[84:87], v10 offset:25856
    ds_read_b128 v[88:91], v10 offset:26880
    ds_read_b128 v[92:95], v10 offset:27904
    ds_read_b128 v[96:99], v6 offset:0
    ds_read_b128 v[100:103], v6 offset:1024
    ds_read_b128 v[104:107], v6 offset:2048
    ds_read_b128 v[108:111], v6 offset:3072
    ds_read_b128 v[112:115], v6 offset:24832
    ds_read_b128 v[116:119], v6 offset:25856
    ds_read_b128 v[120:123], v6 offset:26880
    ds_read_b128 v[124:127], v6 offset:27904
    ds_read_b128 v[128:131], v11 offset:0
    ds_read_b128 v[132:135], v11 offset:1024
    ds_read_b128 v[136:139], v11 offset:2048
    ds_read_b128 v[140:143], v11 offset:3072
    ds_read_b128 v[144:147], v11 offset:24832
    ds_read_b128 v[148:151], v11 offset:25856
    ds_read_b128 v[152:155], v11 offset:26880
    ds_read_b128 v[156:159], v11 offset:27904
    ds_read_b128 v[160:163], v7 offset:0
    ds_read_b128 v[164:167], v7 offset:1024
    ds_read_b128 v[168:171], v7 offset:2048
    ds_read_b128 v[172:175], v7 offset:3072
    ds_read_b128 v[176:179], v7 offset:24832
    ds_read_b128 v[180:183], v7 offset:25856
    ds_read_b128 v[184:187], v7 offset:26880
    ds_read_b128 v[188:191], v7 offset:27904
    v_lshlrev_b32 v8, 2, v4
    v_add_u32 v2, 49664, v8
    ds_read_b32 v48, v8 offset:24576
    ds_read_b32 v49, v8 offset:49408
    ds_read_b32 v50, v2 offset:24576
    ds_read_b32 v51, v2 offset:49408
    s_waitcnt lgkmcnt(15)
    v_pk_add_f32 v[64:65], v[64:65], v[80:81]
    v_pk_add_f32 v[96:97], v[96:97], v[112:113]
    v_pk_add_f32 v[66:67], v[66:67], v[82:83]
    v_pk_add_f32 v[98:99], v[98:99], v[114:115]
    v_pk_add_f32 v[68:69], v[68:69], v[84:85]
    v_pk_add_f32 v[100:101], v[100:101], v[116:117]
    v_pk_add_f32 v[70:71], v[70:71], v[86:87]
    v_pk_add_f32 v[102:103], v[102:103], v[118:119]
    v_pk_add_f32 v[72:73], v[72:73], v[88:89]
    v_pk_add_f32 v[104:105], v[104:105], v[120:121]
    v_pk_add_f32 v[74:75], v[74:75], v[90:91]
    v_pk_add_f32 v[106:107], v[106:107], v[122:123]
    v_pk_add_f32 v[76:77], v[76:77], v[92:93]
    v_pk_add_f32 v[108:109], v[108:109], v[124:125]
    v_pk_add_f32 v[78:79], v[78:79], v[94:95]
    v_pk_add_f32 v[110:111], v[110:111], v[126:127]
    v_pk_add_f32 v[64:65], v[64:65], v[96:97]
    v_pk_add_f32 v[66:67], v[66:67], v[98:99]
    v_pk_add_f32 v[68:69], v[68:69], v[100:101]
    v_pk_add_f32 v[70:71], v[70:71], v[102:103]
    v_pk_add_f32 v[72:73], v[72:73], v[104:105]
    v_pk_add_f32 v[74:75], v[74:75], v[106:107]
    v_pk_add_f32 v[76:77], v[76:77], v[108:109]
    v_pk_add_f32 v[78:79], v[78:79], v[110:111]
    v_pk_mul_f32 v[96:97], v[64:65], s[60:61]
    v_pk_mul_f32 v[98:99], v[66:67], s[60:61]
    v_pk_mul_f32 v[100:101], v[68:69], s[60:61]
    v_pk_mul_f32 v[102:103], v[70:71], s[60:61]
    v_pk_mul_f32 v[104:105], v[72:73], s[60:61]
    v_pk_mul_f32 v[106:107], v[74:75], s[60:61]
    v_pk_mul_f32 v[108:109], v[76:77], s[60:61]
    v_pk_mul_f32 v[110:111], v[78:79], s[60:61]
    v_exp_f32 v96, v96
    v_exp_f32 v97, v97
    v_exp_f32 v98, v98
    v_exp_f32 v99, v99
    v_exp_f32 v100, v100
    v_exp_f32 v101, v101
    v_exp_f32 v102, v102
    v_exp_f32 v103, v103
    v_exp_f32 v104, v104
    v_exp_f32 v105, v105
    v_exp_f32 v106, v106
    v_exp_f32 v107, v107
    v_exp_f32 v108, v108
    v_exp_f32 v109, v109
    v_exp_f32 v110, v110
    v_exp_f32 v111, v111
    v_pk_add_f32 v[96:97], v[96:97], s[62:63]
    v_pk_add_f32 v[98:99], v[98:99], s[62:63]
    v_pk_add_f32 v[100:101], v[100:101], s[62:63]
    v_pk_add_f32 v[102:103], v[102:103], s[62:63]
    v_pk_add_f32 v[104:105], v[104:105], s[62:63]
    v_pk_add_f32 v[106:107], v[106:107], s[62:63]
    v_pk_add_f32 v[108:109], v[108:109], s[62:63]
    v_pk_add_f32 v[110:111], v[110:111], s[62:63]
    v_rcp_f32 v96, v96
    v_rcp_f32 v97, v97
    v_rcp_f32 v98, v98
    v_rcp_f32 v99, v99
    v_rcp_f32 v100, v100
    v_rcp_f32 v101, v101
    v_rcp_f32 v102, v102
    v_rcp_f32 v103, v103
    v_rcp_f32 v104, v104
    v_rcp_f32 v105, v105
    v_rcp_f32 v106, v106
    v_rcp_f32 v107, v107
    v_rcp_f32 v108, v108
    v_rcp_f32 v109, v109
    v_rcp_f32 v110, v110
    v_rcp_f32 v111, v111
    s_waitcnt lgkmcnt(0)
    v_pk_add_f32 v[128:129], v[128:129], v[144:145]
    v_pk_add_f32 v[160:161], v[160:161], v[176:177]
    v_pk_add_f32 v[130:131], v[130:131], v[146:147]
    v_pk_add_f32 v[162:163], v[162:163], v[178:179]
    v_pk_add_f32 v[132:133], v[132:133], v[148:149]
    v_pk_add_f32 v[164:165], v[164:165], v[180:181]
    v_pk_add_f32 v[134:135], v[134:135], v[150:151]
    v_pk_add_f32 v[166:167], v[166:167], v[182:183]
    v_pk_add_f32 v[136:137], v[136:137], v[152:153]
    v_pk_add_f32 v[168:169], v[168:169], v[184:185]
    v_pk_add_f32 v[138:139], v[138:139], v[154:155]
    v_pk_add_f32 v[170:171], v[170:171], v[186:187]
    v_pk_add_f32 v[140:141], v[140:141], v[156:157]
    v_pk_add_f32 v[172:173], v[172:173], v[188:189]
    v_pk_add_f32 v[142:143], v[142:143], v[158:159]
    v_pk_add_f32 v[174:175], v[174:175], v[190:191]
    v_pk_add_f32 v[128:129], v[128:129], v[160:161]
    v_pk_add_f32 v[130:131], v[130:131], v[162:163]
    v_pk_add_f32 v[132:133], v[132:133], v[164:165]
    v_pk_add_f32 v[134:135], v[134:135], v[166:167]
    v_pk_add_f32 v[136:137], v[136:137], v[168:169]
    v_pk_add_f32 v[138:139], v[138:139], v[170:171]
    v_pk_add_f32 v[140:141], v[140:141], v[172:173]
    v_pk_add_f32 v[142:143], v[142:143], v[174:175]
    v_pk_add_f32 v[128:129], v[128:129], v[52:53]
    v_pk_add_f32 v[130:131], v[130:131], v[52:53]
    v_pk_add_f32 v[132:133], v[132:133], v[52:53]
    v_pk_add_f32 v[134:135], v[134:135], v[52:53]
    v_pk_add_f32 v[136:137], v[136:137], v[52:53]
    v_pk_add_f32 v[138:139], v[138:139], v[52:53]
    v_pk_add_f32 v[140:141], v[140:141], v[52:53]
    v_pk_add_f32 v[142:143], v[142:143], v[52:53]
    v_add_f32 v48, v48, v49
    v_add_f32 v50, v50, v51
    v_add_f32 v48, v48, v50
    v_add_f32 v48, v48, v9
    v_cndmask_b32 v128, v128, v48, s[30:31]
    s_or_b32 s27, s6, s23
    v_or_b32 v8, s27, v4
    v_cmp_eq_u32 vcc, 0, v8
    v_mov_b32 v2, 0
    s_nop 0
    s_cbranch_vccz K2_NOCOL
    v_cndmask_b32 v128, v128, v2, vcc
    v_cndmask_b32 v129, v129, v2, vcc
    v_cndmask_b32 v130, v130, v2, vcc
    v_cndmask_b32 v131, v131, v2, vcc
    v_cndmask_b32 v132, v132, v2, vcc
    v_cndmask_b32 v133, v133, v2, vcc
    v_cndmask_b32 v134, v134, v2, vcc
    v_cndmask_b32 v135, v135, v2, vcc
    v_cndmask_b32 v136, v136, v2, vcc
    v_cndmask_b32 v137, v137, v2, vcc
    v_cndmask_b32 v138, v138, v2, vcc
    v_cndmask_b32 v139, v139, v2, vcc
    v_cndmask_b32 v140, v140, v2, vcc
    v_cndmask_b32 v141, v141, v2, vcc
    v_cndmask_b32 v142, v142, v2, vcc
    v_cndmask_b32 v143, v143, v2, vcc
K2_NOCOL:
    v_pk_mul_f32 v[64:65], v[64:65], v[128:129]
    v_pk_mul_f32 v[66:67], v[66:67], v[130:131]
    v_pk_mul_f32 v[68:69], v[68:69], v[132:133]
    v_pk_mul_f32 v[70:71], v[70:71], v[134:135]
    v_pk_mul_f32 v[72:73], v[72:73], v[136:137]
    v_pk_mul_f32 v[74:75], v[74:75], v[138:139]
    v_pk_mul_f32 v[76:77], v[76:77], v[140:141]
    v_pk_mul_f32 v[78:79], v[78:79], v[142:143]
    v_pk_fma_f32 v[64:65], v[64:65], v[96:97], v[32:33]
    v_pk_fma_f32 v[66:67], v[66:67], v[98:99], v[34:35]
    v_pk_fma_f32 v[68:69], v[68:69], v[100:101], v[36:37]
    v_pk_fma_f32 v[70:71], v[70:71], v[102:103], v[38:39]
    v_pk_fma_f32 v[72:73], v[72:73], v[104:105], v[40:41]
    v_pk_fma_f32 v[74:75], v[74:75], v[106:107], v[42:43]
    v_pk_fma_f32 v[76:77], v[76:77], v[108:109], v[44:45]
    v_pk_fma_f32 v[78:79], v[78:79], v[110:111], v[46:47]
    v_cvt_pk_bf16_f32 v64, v64, v65
    v_cvt_pk_bf16_f32 v66, v66, v67
    v_cvt_pk_bf16_f32 v68, v68, v69
    v_cvt_pk_bf16_f32 v70, v70, v71
    v_cvt_pk_bf16_f32 v72, v72, v73
    v_cvt_pk_bf16_f32 v74, v74, v75
    v_cvt_pk_bf16_f32 v76, v76, v77
    v_cvt_pk_bf16_f32 v78, v78, v79
    buffer_store_short v64, v16, s[16:19], 0 offen
    buffer_store_short_d16_hi v64, v17, s[16:19], 0 offen
    buffer_store_short v66, v18, s[16:19], 0 offen
    buffer_store_short_d16_hi v66, v19, s[16:19], 0 offen
    buffer_store_short v68, v20, s[16:19], 0 offen
    buffer_store_short_d16_hi v68, v21, s[16:19], 0 offen
    buffer_store_short v70, v22, s[16:19], 0 offen
    buffer_store_short_d16_hi v70, v23, s[16:19], 0 offen
    buffer_store_short v72, v24, s[16:19], 0 offen
    buffer_store_short_d16_hi v72, v25, s[16:19], 0 offen
    buffer_store_short v74, v26, s[16:19], 0 offen
    buffer_store_short_d16_hi v74, v27, s[16:19], 0 offen
    buffer_store_short v76, v28, s[16:19], 0 offen
    buffer_store_short_d16_hi v76, v29, s[16:19], 0 offen
    buffer_store_short v78, v30, s[16:19], 0 offen
    buffer_store_short_d16_hi v78, v31, s[16:19], 0 offen
K2_END:
    s_endpgm
.section .rodata,"a"
.p2align 6
.amdhsa_kernel fnet_k1_kernel
  .amdhsa_next_free_vgpr 256
  .amdhsa_next_free_sgpr 102
  .amdhsa_accum_offset 256
  .amdhsa_group_segment_fixed_size 0
  .amdhsa_kernarg_size 96
  .amdhsa_user_sgpr_count 2
  .amdhsa_user_sgpr_kernarg_segment_ptr 1
  .amdhsa_system_sgpr_workgroup_id_x 1
.end_amdhsa_kernel
.p2align 6
.amdhsa_kernel fnet_k2_kernel
  .amdhsa_next_free_vgpr 368
  .amdhsa_next_free_sgpr 102
  .amdhsa_accum_offset 256
  .amdhsa_group_segment_fixed_size 0
  .amdhsa_kernarg_size 96
  .amdhsa_user_sgpr_count 2
  .amdhsa_user_sgpr_kernarg_segment_ptr 1
  .amdhsa_system_sgpr_workgroup_id_x 1
.end_amdhsa_kernel
```
